```python
import torch

def _softmax(x, axis=-1):
    return torch.softmax(x, dim=axis)
def _gelu(x):
    return torch.nn.functional.gelu(x, approximate="tanh")
def _silu(x):
    return torch.nn.functional.silu(x)
def _sigmoid(x):
    return torch.sigmoid(x)
def _layernorm(x, axis=-1, eps=1e-5):
    m = x.mean(dim=axis, keepdim=True)
    v = x.var(dim=axis, keepdim=True, unbiased=False)
    return (x - m) / torch.sqrt(v + eps)
def _scatter_add(tgt, idx, src, axis=0):
    return tgt.clone().index_add_(axis, idx, src)
def _segment_sum(src, seg, n):
    out = torch.zeros((n,) + src.shape[1:], dtype=src.dtype)
    return out.index_add_(0, seg, src)
def _pad(x, pw):
    flat = tuple(v for pair in reversed(pw) for v in pair)
    return torch.nn.functional.pad(x, flat)

kernel_name = 'gated_mix__ssm_conv_s4d__linear_kernel_hedgehog__prompt'

def setup_inputs():

    _w = (lambda a: (lambda t: t.to(torch.bfloat16) if t.is_floating_point() else t)(torch.as_tensor(a)))
    def _A_setup():
        Bsz, L, D, N = 1, 2048, 512, 128
        return {
            "u": _w((lambda *s: torch.randn(*s, dtype=torch.bfloat16) * 0.05)(Bsz, L, D)),
            "log_A_real": _w((lambda *s: torch.randn(*s, dtype=torch.bfloat16) * 3.2)(D, N) * 0.5),
            "A_imag": _w((lambda *s: torch.randn(*s, dtype=torch.bfloat16) * 0.05)(D, N) * 3.14),
            "C_real": _w((lambda *s: torch.randn(*s, dtype=torch.bfloat16) * 0.4)(D, N) / N ** 0.5),
            "C_imag": _w((lambda *s: torch.randn(*s, dtype=torch.bfloat16) * 0.4)(D, N) / N ** 0.5),
            "log_dt": _w((lambda *s: torch.randn(*s, dtype=torch.bfloat16) * 0.05)(D) * 0.5 - 4.0),
            "D_skip": _w((lambda *s: torch.randn(*s, dtype=torch.bfloat16) * 0.05)(D)),
        }
    _A_in = _A_setup()

    def _B_setup():
        B, S, D, H = 1, 2048, 512, 32
        Dh = D // H
        return {
            "x": _w((lambda *s: torch.randn(*s, dtype=torch.bfloat16) * 0.05)(B, S, D)),
            "wqkv": _w((lambda *s: torch.randn(*s, dtype=torch.bfloat16) * 0.8)(D, 3 * D)),
            "w_phi": _w((lambda *s: torch.randn(*s, dtype=torch.bfloat16) * 0.8)(H, Dh, Dh) * (Dh ** -0.5)),
            "wo": _w((lambda *s: torch.randn(*s, dtype=torch.bfloat16) * 0.05)(D, D)),
        }
    _B_in = _B_setup()

    return {
        "A_u": _A_in["u"],
        "A_log_A_real": _A_in["log_A_real"],
        "A_A_imag": _A_in["A_imag"],
        "A_C_real": _A_in["C_real"],
        "A_C_imag": _A_in["C_imag"],
        "A_log_dt": _A_in["log_dt"],
        "A_D_skip": _A_in["D_skip"],
        "B_x": _B_in["x"],
        "B_wqkv": _B_in["wqkv"],
        "B_w_phi": _B_in["w_phi"],
        "B_wo": _B_in["wo"],
        "gate_w": _w((lambda *s: torch.randn(*s, dtype=torch.bfloat16) * 0.05)(512) * 16.0),
    }

def reference(A_u, A_log_A_real, A_A_imag, A_C_real, A_C_imag, A_log_dt, A_D_skip, B_x, B_wqkv, B_w_phi, B_wo, gate_w):
    def _A_ref(u, log_A_real, A_imag, C_real, C_imag, log_dt, D_skip):
        L = u.shape[1]
        dt = torch.exp(log_dt)
        A = -torch.exp(log_A_real) + 1j * A_imag
        C = (C_real + 1j * C_imag) * dt[:, None]
        pos = (lambda x, dt: x.to(dt))(torch.arange(L), log_dt.dtype)
        P = torch.exp((A * dt[:, None])[:, :, None] * pos[None, None, :])
        K = 2.0 * torch.einsum("dn,dnl->dl", C, P).real
        L2 = 2 * L
        u_t = (lambda x, *d: x.permute(*d))(u, 0, 2, 1)
        Kf = (lambda x, *a, **k: torch.fft.rfft(x.float(), *a, **k))(K, L2)
        Uf = (lambda x, *a, **k: torch.fft.rfft(x.float(), *a, **k))(u_t, L2)
        y = (lambda x, *a, **k: torch.fft.irfft(x, *a, **k).to(torch.bfloat16))(Uf * Kf[None, :, :], L2)[:, :, :L]
        y = (lambda x, *d: x.permute(*d))(y, 0, 2, 1)
        return y + u * D_skip[None, None, :]

    def _B_ref(x, wqkv, w_phi, wo):
        B, S, D = x.shape
        H = 32; Dh = D // H
        qkv = (lambda x, *d: x.permute(*d))((x @ wqkv).reshape(B, S, 3, H, Dh), 2, 0, 3, 1, 4)
        q, k, v = qkv[0], qkv[1], qkv[2]
        pq = torch.einsum("bhsd,hdf->bhsf", q, w_phi)
        pk = torch.einsum("bhsd,hdf->bhsf", k, w_phi)
        phi_q = torch.concatenate([_softmax(pq, axis=-1), _softmax(-pq, axis=-1)], axis=-1)
        phi_k = torch.concatenate([_softmax(pk, axis=-1), _softmax(-pk, axis=-1)], axis=-1)
        kv = torch.einsum("bhsf,bhsd->bhfd", phi_k, v)
        z  = torch.einsum("bhsf->bhf", phi_k)
        num = torch.einsum("bhqf,bhfd->bhqd", phi_q, kv)
        den = torch.einsum("bhqf,bhf->bhq", phi_q, z)[..., None] + 1e-6
        o = num / den
        return (lambda x, *d: x.permute(*d))(o, 0, 2, 1, 3).reshape(B, S, D) @ wo

    x = A_u
    g = _sigmoid((x * gate_w).sum(-1, keepdims=True))
    a = _A_ref(x, A_log_A_real, A_A_imag, A_C_real, A_C_imag, A_log_dt, A_D_skip)
    b = _B_ref(x, B_wqkv, B_w_phi, B_wo)
    return g * a + (1 - g) * b
```

```asm
; @launch kernel=mix_f_kernel grid=(256,1,1) block=(512,1,1) lds=163840
.amdgcn_target "amdgcn-amd-amdhsa--gfx950"
.text
.globl mix_f_kernel
.p2align 8
.type mix_f_kernel,@function
mix_f_kernel:
  s_cmp_ge_u32 s2, 256
  s_cbranch_scc1 F_END
  s_load_dwordx16 s[8:23], s[0:1], 0
  s_load_dwordx8 s[24:31], s[0:1], 64
  s_load_dwordx4 s[32:35], s[0:1], 96
  s_load_dwordx2 s[36:37], s[0:1], 112
  v_lshrrev_b32 v2, 6, v0
  v_and_b32 v1, 63, v0
  v_readfirstlane_b32 s4, v2
  s_cmp_ge_u32 s2, 128
  s_cbranch_scc1 A_ROLE
  s_and_b32 s62, s2, 7
  s_lshr_b32 s63, s2, 3
  s_lshr_b32 s5, s62, 1
  s_lshl_b32 s5, s5, 2
  s_and_b32 s64, s63, 3
  s_add_u32 s5, s5, s64
  s_and_b32 s62, s62, 1
  s_lshr_b32 s63, s63, 2
  s_lshl_b32 s6, s62, 2
  s_add_u32 s6, s6, s63
  s_lshr_b32 s101, s4, 2
  v_lshrrev_b32 v2, 3, v1
  v_and_b32 v3, 7, v1
  v_lshrrev_b32 v4, 4, v1
  v_xor_b32 v6, v3, v4
  v_lshlrev_b32 v6, 4, v6
  v_lshl_add_u32 v6, v2, 10, v6
  v_xor_b32 v7, 64, v6
  v_add_u32 v7, 8192, v7
  v_and_b32 v4, 1, v4
  v_lshlrev_b32 v4, 2, v4
  v_xor_b32 v3, v3, v4
  v_lshlrev_b32 v3, 4, v3
  v_mul_u32_u24 v8, 3072, v2
  v_add_u32 v8, v8, v3
  s_lshl_b32 s99, s5, 3
  s_add_u32 s99, s99, s4
  s_lshl_b32 s99, s99, 14
  s_mul_i32 s100, s4, 24576
  s_lshl_b32 s62, s6, 7
  s_add_u32 s100, s100, s62
  s_lshl_b32 s65, s4, 11
  s_lshl_b32 s98, s4, 10
  s_lshl_b32 s62, s6, 3
  s_add_u32 s62, s62, s4
  s_mul_i32 s7, s62, 10240
  s_add_u32 s7, s7, 0x400000
  s_mul_i32 s62, s5, 640
  s_add_u32 s3, s7, s62
  v_lshl_add_u32 v4, v1, 4, s3
  v_cmp_gt_u32 vcc, 36, v1
  v_mov_b32 v5, 0x80000000
  s_nop 0
  v_cndmask_b32 v4, v5, v4, vcc
  v_mov_b32 v16, -1
  v_mov_b32 v17, -1
  v_mov_b32 v18, -1
  v_mov_b32 v19, -1
  s_waitcnt lgkmcnt(0)
  s_mov_b32 s40, s8
  s_and_b32 s41, s9, 0xffff
  s_mov_b32 s42, 0x200000
  s_mov_b32 s43, 0x20000
  s_mov_b32 s44, s24
  s_and_b32 s45, s25, 0xffff
  s_mov_b32 s46, 0x180000
  s_mov_b32 s47, 0x20000
  s_mov_b32 s48, s36
  s_and_b32 s49, s37, 0xffff
  s_mov_b32 s50, 0x1000000
  s_mov_b32 s51, 0x20000
  v_mov_b32 v120, v4
  buffer_store_dwordx4 v[16:19], v120, s[48:51], 0 offen sc1
  s_add_u32 m0, s65, 0
  s_add_u32 s10, s99, 0
  buffer_load_dwordx4 v6, s[40:43], s10 offen lds
  s_add_u32 m0, s65, 1024
  s_add_u32 s10, s99, 0
  buffer_load_dwordx4 v7, s[40:43], s10 offen lds
  s_add_u32 m0, s98, 64512
  s_add_u32 s10, s100, 0
  buffer_load_dwordx4 v8, s[44:47], s10 offen offset:1024 lds
  s_add_u32 m0, s98, 71680
  s_add_u32 s10, s100, 0
  buffer_load_dwordx4 v8, s[44:47], s10 offen offset:2048 lds
  s_barrier
  s_mov_b32 s52, s26
  s_and_b32 s53, s27, 0xffff
  s_mov_b32 s54, 0x4000
  s_mov_b32 s55, 0x20000
  v_lshlrev_b32 v2, 2, v1
  s_lshl_b32 s62, s6, 3
  s_add_u32 s62, s62, s4
  s_lshl_b32 s62, s62, 8
  s_lshl_b32 s63, s4, 8
  s_add_u32 m0, s63, 131072
  s_nop 0
  buffer_load_dword v2, s[52:55], s62 offen lds
  s_mov_b32 s56, s30
  s_and_b32 s57, s31, 0xffff
  s_mov_b32 s58, 0x400
  s_mov_b32 s59, 0x20000
  v_lshrrev_b32 v3, 5, v1
  v_lshlrev_b32 v4, 4, v3
  s_lshl_b32 s19, s6, 1
  s_add_u32 s19, s19, s101
  s_lshl_b32 s63, s19, 6
  buffer_load_dwordx4 v[112:115], v4, s[56:59], s63 offen
  buffer_load_dwordx4 v[116:119], v4, s[56:59], s63 offen offset:32
  s_mul_i32 s62, s2, 6144
  s_add_u32 s63, s62, 787456
  s_lshl_b32 s62, s62, 1
  s_cmp_eq_u32 s4, 0
  s_cselect_b32 s62, s63, s62
  s_cselect_b32 s63, 5, 4
  v_lshrrev_b32 v4, s63, v1
  v_lshlrev_b32 v5, s63, v4
  v_sub_u32 v5, v1, v5
  s_lshl_b32 s64, s2, 12
  s_cmp_eq_u32 s4, 2
  s_cselect_b32 s62, s64, s62
  s_cselect_b32 s63, 1, 3
  s_cselect_b32 s26, s28, s24
  s_cselect_b32 s27, s29, s25
  s_lshl_b32 s63, s63, 10
  v_mul_u32_u24 v4, s63, v4
  v_lshl_add_u32 v4, v5, 6, v4
  v_add_u32 v4, s62, v4
  s_cmp_gt_u32 s4, 2
  s_cselect_b32 s62, 0, -1
  v_and_b32 v20, s62, v4
  s_mov_b32 s52, s28
  s_and_b32 s53, s29, 0xffff
  s_mov_b32 s54, 0x80000
  s_mov_b32 s55, 0x20000
  v_lshrrev_b32 v4, 3, v1
  v_and_b32 v4, 4, v4
  s_and_b32 s62, s4, 1
  s_lshl_b32 s62, s62, 1
  v_xor_b32 v4, s62, v4
  s_add_u32 m0, s65, 16384
  s_add_u32 s10, s99, 128
  buffer_load_dwordx4 v6, s[40:43], s10 offen lds
  v_and_b32 v5, 7, v1
  v_xor_b32 v4, v4, v5
  v_lshlrev_b32 v4, 4, v4
  v_lshrrev_b32 v5, 3, v1
  v_lshl_add_u32 v9, v5, 10, v4
  s_and_b32 s62, s2, 7
  s_lshr_b32 s63, s2, 3
  s_lshr_b32 s39, s63, 2
  s_and_b32 s63, s63, 3
  s_lshl_b32 s38, s62, 2
  s_add_u32 m0, s65, 17408
  s_add_u32 s10, s99, 128
  buffer_load_dwordx4 v7, s[40:43], s10 offen lds
  s_add_u32 s38, s38, s63
  s_lshl_b32 s22, s4, 13
  s_lshl_b32 s63, s39, 7
  s_add_u32 s22, s22, s63
  s_lshl_b32 s23, s4, 12
  s_and_b32 s62, s4, 3
  s_lshr_b32 s63, s4, 2
  s_lshl_b32 s64, s38, 2
  s_add_u32 s62, s62, s64
  s_lshl_b32 s16, s62, 14
  s_add_u32 m0, s98, 80896
  s_add_u32 s10, s100, 196608
  buffer_load_dwordx4 v8, s[44:47], s10 offen offset:1024 lds
  s_lshl_b32 s64, s63, 13
  s_add_u32 s12, s16, s64
  s_add_u32 s12, s12, 0x200000
  s_add_u32 s13, s12, 4096
  s_lshl_b32 s64, s39, 1
  s_add_u32 s64, s64, s63
  s_lshl_b32 s14, s64, 17
  s_lshl_b32 s64, s64, 6
  s_add_u32 s16, s16, s64
  s_lshl_b32 s64, s62, 7
  s_add_u32 m0, s98, 88064
  s_add_u32 s10, s100, 196608
  buffer_load_dwordx4 v8, s[44:47], s10 offen offset:2048 lds
  s_add_u32 s14, s14, s64
  s_add_u32 s20, s14, 65536
  s_lshr_b32 s64, s62, 1
  s_lshl_b32 s15, s64, 11
  s_and_b32 s64, s62, 1
  s_lshl_b32 s64, s64, 6
  s_add_u32 s15, s15, s64
  s_add_u32 s15, s15, 0x520000
  v_lshrrev_b32 v3, 5, v1
  v_and_b32 v2, 31, v1
  s_add_u32 m0, s65, 32768
  s_add_u32 s10, s99, 256
  buffer_load_dwordx4 v6, s[40:43], s10 offen lds
  v_bfe_u32 v4, v1, 1, 3
  v_xor_b32 v4, v4, v3
  v_lshlrev_b32 v4, 4, v4
  v_lshl_add_u32 v10, v2, 7, v4
  s_and_b32 s62, s4, 3
  s_lshl_b32 s64, s62, 12
  v_add_u32 v10, s64, v10
  v_xor_b32 v11, 32, v10
  v_xor_b32 v12, 64, v10
  v_xor_b32 v13, 96, v10
  s_add_u32 m0, s65, 33792
  s_add_u32 s10, s99, 256
  buffer_load_dwordx4 v7, s[40:43], s10 offen lds
  v_bfe_u32 v108, v1, 2, 2
  v_and_b32 v109, 3, v1
  v_lshlrev_b32 v109, 3, v109
  v_bfe_u32 v4, v1, 4, 1
  v_lshl_add_u32 v109, v4, 5, v109
  v_bfe_u32 v5, v1, 3, 1
  v_lshl_add_u32 v109, v5, 6, v109
  s_lshl_b32 s64, s101, 6
  v_xor_b32 v15, s64, v109
  v_lshl_add_u32 v5, v3, 3, v108
  s_add_u32 m0, s98, 97280
  s_add_u32 s10, s100, 393216
  buffer_load_dwordx4 v8, s[44:47], s10 offen offset:1024 lds
  v_lshl_add_u32 v15, v5, 7, v15
  v_add_u32 v14, 65536, v15
  v_lshl_add_u32 v5, v3, 2, v108
  v_lshlrev_b32 v120, 5, v5
  v_lshl_add_u32 v120, v4, 4, v120
  v_bfe_u32 v5, v1, 1, 1
  v_lshl_add_u32 v120, v5, 3, v120
  s_lshl_b32 s64, s101, 10
  s_add_u32 s64, s64, 131072
  v_add_u32 v120, s64, v120
  s_add_u32 m0, s98, 104448
  s_add_u32 s10, s100, 393216
  buffer_load_dwordx4 v8, s[44:47], s10 offen offset:2048 lds
  s_mov_b32 s60, 0x3fb8aa3b
  s_mov_b32 s61, 0xbfb8aa3b
  s_lshl_b32 s64, s62, 10
  v_lshl_add_u32 v5, v2, 5, s64
  v_lshl_add_u32 v110, v3, 4, v5
  s_lshl_b32 s64, s101, 13
  s_add_u32 s64, s64, 98304
  v_add_u32 v110, s64, v110
  v_lshl_add_u32 v111, v3, 13, v5
  s_lshl_b32 s64, s101, 14
  s_add_u32 m0, s65, 49152
  s_add_u32 s10, s99, 384
  buffer_load_dwordx4 v6, s[40:43], s10 offen lds
  s_add_u32 s64, s64, 131072
  v_add_u32 v111, s64, v111
  s_lshl_b32 s62, s4, 12
  s_add_u32 s62, s62, 131072
  v_lshl_add_u32 v124, v1, 3, s62
  s_lshr_b32 s62, s4, 1
  s_lshl_b32 s62, s62, 12
  s_add_u32 s62, s62, 98304
  v_lshl_add_u32 v125, v1, 3, s62
  v_lshlrev_b32 v4, 2, v1
  s_add_u32 m0, s65, 50176
  s_add_u32 s10, s99, 384
  buffer_load_dwordx4 v7, s[40:43], s10 offen lds
  v_cmp_gt_u32 vcc, 16, v1
  v_mov_b32 v123, 0x80000000
  s_nop 0
  v_cndmask_b32 v123, v123, v4, vcc
  v_and_b32 v4, 15, v1
  v_lshlrev_b32 v122, 5, v4
  v_lshl_add_u32 v122, v3, 4, v122
  v_bfe_u32 v4, v1, 4, 1
  v_lshl_or_b32 v122, v4, 31, v122
  v_bfe_u32 v4, v1, 4, 1
  v_lshlrev_b32 v121, 14, v4
  s_add_u32 m0, s98, 113664
  s_add_u32 s10, s100, 589824
  buffer_load_dwordx4 v8, s[44:47], s10 offen offset:1024 lds
  v_and_b32 v4, 15, v1
  v_lshl_add_u32 v121, v4, 4, v121
  v_lshl_add_u32 v121, v3, 9, v121
  v_lshlrev_b32 v108, 2, v2
  v_lshl_or_b32 v108, v3, 31, v108
  s_lshl_b32 s64, s5, 2
  s_and_b32 s63, s4, 3
  s_add_u32 s64, s64, s63
  s_lshl_b32 s17, s64, 5
  s_add_u32 s17, s17, s19
  s_add_u32 m0, s98, 120832
  s_add_u32 s10, s100, 589824
  buffer_load_dwordx4 v8, s[44:47], s10 offen offset:2048 lds
  s_lshl_b32 s17, s17, 10
  s_add_u32 s17, s17, 0x200000
  s_lshl_b32 s64, s64, 4
  s_add_u32 s64, s64, s19
  s_lshl_b32 s18, s64, 7
  s_add_u32 s18, s18, 0x520000
  v_mov_b32 v104, -1
  v_mov_b32 v105, -1
  v_mov_b32 v106, -1
  v_mov_b32 v107, -1
  global_load_dword v127, v20, s[26:27]
  s_waitcnt vmcnt(20)
  s_waitcnt vmcnt(16)
  s_barrier
  ds_read_b128 a[0:3], v10 offset:0
  ds_read_b64_tr_b16 v[48:49], v14 offset:0
  ds_read_b64_tr_b16 v[50:51], v14 offset:512
  ds_read_b64_tr_b16 v[52:53], v14 offset:8192
  ds_read_b64_tr_b16 v[54:55], v14 offset:8704
  ds_read_b128 a[4:7], v11 offset:0
  ds_read_b64_tr_b16 v[56:57], v14 offset:2048
  ds_read_b64_tr_b16 v[58:59], v14 offset:2560
  ds_read_b64_tr_b16 v[60:61], v14 offset:10240
  ds_read_b64_tr_b16 v[62:63], v14 offset:10752
  ds_read_b128 a[8:11], v12 offset:0
  ds_read_b64_tr_b16 v[64:65], v14 offset:4096
  ds_read_b64_tr_b16 v[66:67], v14 offset:4608
  ds_read_b64_tr_b16 v[68:69], v14 offset:12288
  ds_read_b64_tr_b16 v[70:71], v14 offset:12800
  ds_read_b128 a[12:15], v13 offset:0
  ds_read_b64_tr_b16 v[72:73], v14 offset:6144
  ds_read_b64_tr_b16 v[74:75], v14 offset:6656
  ds_read_b64_tr_b16 v[76:77], v14 offset:14336
  ds_read_b64_tr_b16 v[78:79], v14 offset:14848
  s_cmp_lg_u32 s4, 0
  s_cbranch_scc1 B_NOZ
  s_lshl_b32 s64, s6, 5
  v_mov_b32 v4, s64
  v_mov_b32 v5, 1
  s_mov_b64 exec, 1
  global_atomic_add v4, v5, s[34:35] sc1
  s_mov_b64 exec, -1
B_NOZ:
  s_waitcnt lgkmcnt(15)
  v_mfma_f32_32x32x16_bf16 v[16:31], v[48:51], a[0:3], 0
  v_mfma_f32_32x32x16_bf16 v[32:47], v[52:55], a[0:3], 0
  s_waitcnt lgkmcnt(12)
  v_mfma_f32_32x32x16_bf16 v[16:31], v[56:59], a[4:7], v[16:31]
  s_waitcnt lgkmcnt(10)
  v_mfma_f32_32x32x16_bf16 v[32:47], v[60:63], a[4:7], v[32:47]
  s_waitcnt vmcnt(9) lgkmcnt(0)
  s_barrier
  v_mfma_f32_32x32x16_bf16 v[16:31], v[64:67], a[8:11], v[16:31]
  ds_read_b128 a[16:19], v10 offset:16384
  ds_read_b64_tr_b16 v[48:49], v14 offset:16384
  ds_read_b64_tr_b16 v[50:51], v14 offset:16896
  v_mfma_f32_32x32x16_bf16 v[32:47], v[68:71], a[8:11], v[32:47]
  ds_read_b64_tr_b16 v[52:53], v14 offset:24576
  ds_read_b64_tr_b16 v[54:55], v14 offset:25088
  ds_read_b128 a[20:23], v11 offset:16384
  v_mfma_f32_32x32x16_bf16 v[16:31], v[72:75], a[12:15], v[16:31]
  ds_read_b64_tr_b16 v[56:57], v14 offset:18432
  ds_read_b64_tr_b16 v[58:59], v14 offset:18944
  ds_read_b64_tr_b16 v[60:61], v14 offset:26624
  s_add_u32 m0, s65, 0
  s_add_u32 s62, s99, 512
  buffer_load_dwordx4 v6, s[40:43], s62 offen lds
  v_mfma_f32_32x32x16_bf16 v[32:47], v[76:79], a[12:15], v[32:47]
  ds_read_b64_tr_b16 v[62:63], v14 offset:27136
  ds_read_b128 a[24:27], v12 offset:16384
  ds_read_b64_tr_b16 v[64:65], v14 offset:20480
  s_cmp_lg_u32 s19, 0
  s_cbranch_scc1 B_NG0_0
  v_mfma_f32_32x32x16_bf16 v[88:103], v[112:115], a[0:3], 0
  v_mfma_f32_32x32x16_bf16 v[88:103], v[116:119], a[4:7], v[88:103]
B_NG0_0:
  s_cmp_lg_u32 s19, 1
  s_cbranch_scc1 B_NG0_1
  v_mfma_f32_32x32x16_bf16 v[88:103], v[112:115], a[8:11], 0
  v_mfma_f32_32x32x16_bf16 v[88:103], v[116:119], a[12:15], v[88:103]
B_NG0_1:
  s_waitcnt lgkmcnt(9)
  v_mfma_f32_32x32x16_bf16 v[16:31], v[48:51], a[16:19], v[16:31]
  ds_read_b64_tr_b16 v[66:67], v14 offset:20992
  ds_read_b64_tr_b16 v[68:69], v14 offset:28672
  ds_read_b64_tr_b16 v[70:71], v14 offset:29184
  s_add_u32 m0, s65, 1024
  s_add_u32 s62, s99, 512
  buffer_load_dwordx4 v7, s[40:43], s62 offen lds
  s_waitcnt lgkmcnt(10)
  v_mfma_f32_32x32x16_bf16 v[32:47], v[52:55], a[16:19], v[32:47]
  ds_read_b128 a[28:31], v13 offset:16384
  ds_read_b64_tr_b16 v[72:73], v14 offset:22528
  ds_read_b64_tr_b16 v[74:75], v14 offset:23040
  s_waitcnt lgkmcnt(10)
  v_mfma_f32_32x32x16_bf16 v[16:31], v[56:59], a[20:23], v[16:31]
  ds_read_b64_tr_b16 v[76:77], v14 offset:30720
  ds_read_b64_tr_b16 v[78:79], v14 offset:31232
  s_add_u32 m0, s98, 64512
  s_add_u32 s62, s100, 786432
  buffer_load_dwordx4 v8, s[44:47], s62 offen offset:1024 lds
  ds_read_b64_tr_b16 v[80:81], v120 offset:0
  ds_read_b64_tr_b16 v[82:83], v120 offset:256
  ds_read_b64_tr_b16 v[84:85], v120 offset:512
  ds_read_b64_tr_b16 v[86:87], v120 offset:768
  s_waitcnt lgkmcnt(14)
  v_mfma_f32_32x32x16_bf16 v[32:47], v[60:63], a[20:23], v[32:47]
  s_add_u32 m0, s98, 71680
  s_add_u32 s62, s100, 786432
  buffer_load_dwordx4 v8, s[44:47], s62 offen offset:2048 lds
  s_waitcnt vmcnt(9) lgkmcnt(0)
  s_barrier
  v_mfma_f32_32x32x16_bf16 v[16:31], v[64:67], a[24:27], v[16:31]
  ds_read_b128 a[32:35], v10 offset:32768
  ds_read_b64_tr_b16 v[48:49], v14 offset:32768
  ds_read_b64_tr_b16 v[50:51], v14 offset:33280
  v_mfma_f32_32x32x16_bf16 v[32:47], v[68:71], a[24:27], v[32:47]
  ds_read_b64_tr_b16 v[52:53], v14 offset:40960
  ds_read_b64_tr_b16 v[54:55], v14 offset:41472
  ds_read_b128 a[36:39], v11 offset:32768
  v_mfma_f32_32x32x16_bf16 v[16:31], v[72:75], a[28:31], v[16:31]
  ds_read_b64_tr_b16 v[56:57], v14 offset:34816
  ds_read_b64_tr_b16 v[58:59], v14 offset:35328
  ds_read_b64_tr_b16 v[60:61], v14 offset:43008
  s_add_u32 m0, s65, 16384
  s_add_u32 s62, s99, 640
  buffer_load_dwordx4 v6, s[40:43], s62 offen lds
  v_mfma_f32_32x32x16_bf16 v[32:47], v[76:79], a[28:31], v[32:47]
  ds_read_b64_tr_b16 v[62:63], v14 offset:43520
  ds_read_b128 a[40:43], v12 offset:32768
  ds_read_b64_tr_b16 v[64:65], v14 offset:36864
  s_cmp_lg_u32 s19, 2
  s_cbranch_scc1 B_NG1_0
  v_mfma_f32_32x32x16_bf16 v[88:103], v[112:115], a[16:19], 0
  v_mfma_f32_32x32x16_bf16 v[88:103], v[116:119], a[20:23], v[88:103]
B_NG1_0:
  s_cmp_lg_u32 s19, 3
  s_cbranch_scc1 B_NG1_1
  v_mfma_f32_32x32x16_bf16 v[88:103], v[112:115], a[24:27], 0
  v_mfma_f32_32x32x16_bf16 v[88:103], v[116:119], a[28:31], v[88:103]
B_NG1_1:
  s_waitcnt lgkmcnt(9)
  v_mfma_f32_32x32x16_bf16 v[16:31], v[48:51], a[32:35], v[16:31]
  ds_read_b64_tr_b16 v[66:67], v14 offset:37376
  ds_read_b64_tr_b16 v[68:69], v14 offset:45056
  ds_read_b64_tr_b16 v[70:71], v14 offset:45568
  s_add_u32 m0, s65, 17408
  s_add_u32 s62, s99, 640
  buffer_load_dwordx4 v7, s[40:43], s62 offen lds
  s_waitcnt lgkmcnt(10)
  v_mfma_f32_32x32x16_bf16 v[32:47], v[52:55], a[32:35], v[32:47]
  ds_read_b128 a[44:47], v13 offset:32768
  ds_read_b64_tr_b16 v[72:73], v14 offset:38912
  ds_read_b64_tr_b16 v[74:75], v14 offset:39424
  s_waitcnt lgkmcnt(10)
  v_mfma_f32_32x32x16_bf16 v[16:31], v[56:59], a[36:39], v[16:31]
  ds_read_b64_tr_b16 v[76:77], v14 offset:47104
  ds_read_b64_tr_b16 v[78:79], v14 offset:47616
  s_add_u32 m0, s98, 80896
  s_add_u32 s62, s100, 983040
  buffer_load_dwordx4 v8, s[44:47], s62 offen offset:1024 lds
  v_bfe_u32 v5, v1, 2, 1
  v_cmp_eq_u32 vcc, 0, v5
  s_nop 1
  v_cndmask_b32 v80, 0, v80, vcc
  v_cndmask_b32 v84, v84, 0, vcc
  v_cndmask_b32 v81, 0, v81, vcc
  v_cndmask_b32 v85, v85, 0, vcc
  v_cndmask_b32 v82, 0, v82, vcc
  v_cndmask_b32 v86, v86, 0, vcc
  v_cndmask_b32 v83, 0, v83, vcc
  v_cndmask_b32 v87, v87, 0, vcc
  s_waitcnt lgkmcnt(10)
  v_mfma_f32_32x32x16_bf16 v[32:47], v[60:63], a[36:39], v[32:47]
  s_add_u32 m0, s98, 88064
  s_add_u32 s62, s100, 983040
  buffer_load_dwordx4 v8, s[44:47], s62 offen offset:2048 lds
  s_waitcnt vmcnt(9) lgkmcnt(0)
  s_barrier
  v_mfma_f32_32x32x16_bf16 v[16:31], v[64:67], a[40:43], v[16:31]
  ds_read_b128 a[48:51], v10 offset:49152
  ds_read_b64_tr_b16 v[48:49], v14 offset:49152
  ds_read_b64_tr_b16 v[50:51], v14 offset:49664
  v_mfma_f32_32x32x16_bf16 v[32:47], v[68:71], a[40:43], v[32:47]
  ds_read_b64_tr_b16 v[52:53], v14 offset:57344
  ds_read_b64_tr_b16 v[54:55], v14 offset:57856
  ds_read_b128 a[52:55], v11 offset:49152
  v_mfma_f32_32x32x16_bf16 v[16:31], v[72:75], a[44:47], v[16:31]
  ds_read_b64_tr_b16 v[56:57], v14 offset:51200
  ds_read_b64_tr_b16 v[58:59], v14 offset:51712
  ds_read_b64_tr_b16 v[60:61], v14 offset:59392
  s_add_u32 m0, s65, 32768
  s_add_u32 s62, s99, 768
  buffer_load_dwordx4 v6, s[40:43], s62 offen lds
  v_mfma_f32_32x32x16_bf16 v[32:47], v[76:79], a[44:47], v[32:47]
  ds_read_b64_tr_b16 v[62:63], v14 offset:59904
  ds_read_b128 a[56:59], v12 offset:49152
  ds_read_b64_tr_b16 v[64:65], v14 offset:53248
  s_cmp_lg_u32 s19, 4
  s_cbranch_scc1 B_NG2_0
  v_mfma_f32_32x32x16_bf16 v[88:103], v[112:115], a[32:35], 0
  v_mfma_f32_32x32x16_bf16 v[88:103], v[116:119], a[36:39], v[88:103]
B_NG2_0:
  s_cmp_lg_u32 s19, 5
  s_cbranch_scc1 B_NG2_1
  v_mfma_f32_32x32x16_bf16 v[88:103], v[112:115], a[40:43], 0
  v_mfma_f32_32x32x16_bf16 v[88:103], v[116:119], a[44:47], v[88:103]
B_NG2_1:
  s_waitcnt lgkmcnt(9)
  v_mfma_f32_32x32x16_bf16 v[16:31], v[48:51], a[48:51], v[16:31]
  ds_read_b64_tr_b16 v[66:67], v14 offset:53760
  ds_read_b64_tr_b16 v[68:69], v14 offset:61440
  ds_read_b64_tr_b16 v[70:71], v14 offset:61952
  s_add_u32 m0, s65, 33792
  s_add_u32 s62, s99, 768
  buffer_load_dwordx4 v7, s[40:43], s62 offen lds
  s_waitcnt lgkmcnt(10)
  v_mfma_f32_32x32x16_bf16 v[32:47], v[52:55], a[48:51], v[32:47]
  ds_read_b128 a[60:63], v13 offset:49152
  ds_read_b64_tr_b16 v[72:73], v14 offset:55296
  ds_read_b64_tr_b16 v[74:75], v14 offset:55808
  s_waitcnt lgkmcnt(10)
  v_mfma_f32_32x32x16_bf16 v[16:31], v[56:59], a[52:55], v[16:31]
  ds_read_b64_tr_b16 v[76:77], v14 offset:63488
  ds_read_b64_tr_b16 v[78:79], v14 offset:64000
  s_add_u32 m0, s98, 97280
  s_add_u32 s62, s100, 1179648
  buffer_load_dwordx4 v8, s[44:47], s62 offen offset:1024 lds
  s_waitcnt lgkmcnt(10)
  v_mfma_f32_32x32x16_bf16 v[32:47], v[60:63], a[52:55], v[32:47]
  s_add_u32 m0, s98, 104448
  s_add_u32 s62, s100, 1179648
  buffer_load_dwordx4 v8, s[44:47], s62 offen offset:2048 lds
  s_waitcnt vmcnt(8) lgkmcnt(0)
  s_barrier
  v_mfma_f32_32x32x16_bf16 v[16:31], v[64:67], a[56:59], v[16:31]
  ds_read_b128 a[64:67], v10 offset:0
  ds_read_b64_tr_b16 v[48:49], v14 offset:0
  ds_read_b64_tr_b16 v[50:51], v14 offset:512
  v_mfma_f32_32x32x16_bf16 v[32:47], v[68:71], a[56:59], v[32:47]
  ds_read_b64_tr_b16 v[52:53], v14 offset:8192
  ds_read_b64_tr_b16 v[54:55], v14 offset:8704
  ds_read_b128 a[68:71], v11 offset:0
  v_mfma_f32_32x32x16_bf16 v[16:31], v[72:75], a[60:63], v[16:31]
  ds_read_b64_tr_b16 v[56:57], v14 offset:2048
  ds_read_b64_tr_b16 v[58:59], v14 offset:2560
  ds_read_b64_tr_b16 v[60:61], v14 offset:10240
  s_add_u32 m0, s65, 49152
  s_add_u32 s62, s99, 896
  buffer_load_dwordx4 v6, s[40:43], s62 offen lds
  v_mfma_f32_32x32x16_bf16 v[32:47], v[76:79], a[60:63], v[32:47]
  ds_read_b64_tr_b16 v[62:63], v14 offset:10752
  ds_read_b128 a[72:75], v12 offset:0
  ds_read_b64_tr_b16 v[64:65], v14 offset:4096
  s_cmp_lg_u32 s19, 6
  s_cbranch_scc1 B_NG3_0
  v_mfma_f32_32x32x16_bf16 v[88:103], v[112:115], a[48:51], 0
  v_mfma_f32_32x32x16_bf16 v[88:103], v[116:119], a[52:55], v[88:103]
B_NG3_0:
  s_cmp_lg_u32 s19, 7
  s_cbranch_scc1 B_NG3_1
  v_mfma_f32_32x32x16_bf16 v[88:103], v[112:115], a[56:59], 0
  v_mfma_f32_32x32x16_bf16 v[88:103], v[116:119], a[60:63], v[88:103]
B_NG3_1:
  s_waitcnt lgkmcnt(9)
  v_mfma_f32_32x32x16_bf16 v[16:31], v[48:51], a[64:67], v[16:31]
  ds_read_b64_tr_b16 v[66:67], v14 offset:4608
  ds_read_b64_tr_b16 v[68:69], v14 offset:12288
  ds_read_b64_tr_b16 v[70:71], v14 offset:12800
  s_add_u32 m0, s65, 50176
  s_add_u32 s62, s99, 896
  buffer_load_dwordx4 v7, s[40:43], s62 offen lds
  s_waitcnt lgkmcnt(10)
  v_mfma_f32_32x32x16_bf16 v[32:47], v[52:55], a[64:67], v[32:47]
  ds_read_b128 a[76:79], v13 offset:0
  ds_read_b64_tr_b16 v[72:73], v14 offset:6144
  ds_read_b64_tr_b16 v[74:75], v14 offset:6656
  s_waitcnt lgkmcnt(10)
  v_mfma_f32_32x32x16_bf16 v[16:31], v[56:59], a[68:71], v[16:31]
  ds_read_b64_tr_b16 v[76:77], v14 offset:14336
  ds_read_b64_tr_b16 v[78:79], v14 offset:14848
  s_add_u32 m0, s98, 113664
  s_add_u32 s62, s100, 1376256
  buffer_load_dwordx4 v8, s[44:47], s62 offen offset:1024 lds
  s_waitcnt lgkmcnt(10)
  v_mfma_f32_32x32x16_bf16 v[32:47], v[60:63], a[68:71], v[32:47]
  s_add_u32 m0, s98, 120832
  s_add_u32 s62, s100, 1376256
  buffer_load_dwordx4 v8, s[44:47], s62 offen offset:2048 lds
  s_waitcnt vmcnt(8) lgkmcnt(0)
  s_barrier
  v_mfma_f32_32x32x16_bf16 v[16:31], v[64:67], a[72:75], v[16:31]
  ds_read_b128 a[80:83], v10 offset:16384
  ds_read_b64_tr_b16 v[48:49], v14 offset:16384
  ds_read_b64_tr_b16 v[50:51], v14 offset:16896
  v_mfma_f32_32x32x16_bf16 v[32:47], v[68:71], a[72:75], v[32:47]
  ds_read_b64_tr_b16 v[52:53], v14 offset:24576
  ds_read_b64_tr_b16 v[54:55], v14 offset:25088
  ds_read_b128 a[84:87], v11 offset:16384
  v_mfma_f32_32x32x16_bf16 v[16:31], v[72:75], a[76:79], v[16:31]
  ds_read_b64_tr_b16 v[56:57], v14 offset:18432
  ds_read_b64_tr_b16 v[58:59], v14 offset:18944
  ds_read_b64_tr_b16 v[60:61], v14 offset:26624
  s_add_u32 m0, s98, 0
  s_add_u32 s62, s100, 0
  buffer_load_dwordx4 v8, s[44:47], s62 offen lds
  v_mfma_f32_32x32x16_bf16 v[32:47], v[76:79], a[76:79], v[32:47]
  ds_read_b64_tr_b16 v[62:63], v14 offset:27136
  ds_read_b128 a[88:91], v12 offset:16384
  ds_read_b64_tr_b16 v[64:65], v14 offset:20480
  s_cmp_lg_u32 s19, 8
  s_cbranch_scc1 B_NG4_0
  v_mfma_f32_32x32x16_bf16 v[88:103], v[112:115], a[64:67], 0
  v_mfma_f32_32x32x16_bf16 v[88:103], v[116:119], a[68:71], v[88:103]
B_NG4_0:
  s_cmp_lg_u32 s19, 9
  s_cbranch_scc1 B_NG4_1
  v_mfma_f32_32x32x16_bf16 v[88:103], v[112:115], a[72:75], 0
  v_mfma_f32_32x32x16_bf16 v[88:103], v[116:119], a[76:79], v[88:103]
B_NG4_1:
  s_waitcnt lgkmcnt(9)
  v_mfma_f32_32x32x16_bf16 v[16:31], v[48:51], a[80:83], v[16:31]
  ds_read_b64_tr_b16 v[66:67], v14 offset:20992
  ds_read_b64_tr_b16 v[68:69], v14 offset:28672
  ds_read_b64_tr_b16 v[70:71], v14 offset:29184
  s_add_u32 m0, s98, 8192
  s_add_u32 s62, s100, 196608
  buffer_load_dwordx4 v8, s[44:47], s62 offen lds
  s_waitcnt lgkmcnt(10)
  v_mfma_f32_32x32x16_bf16 v[32:47], v[52:55], a[80:83], v[32:47]
  ds_read_b128 a[92:95], v13 offset:16384
  ds_read_b64_tr_b16 v[72:73], v14 offset:22528
  ds_read_b64_tr_b16 v[74:75], v14 offset:23040
  s_waitcnt lgkmcnt(10)
  v_mfma_f32_32x32x16_bf16 v[16:31], v[56:59], a[84:87], v[16:31]
  ds_read_b64_tr_b16 v[76:77], v14 offset:30720
  ds_read_b64_tr_b16 v[78:79], v14 offset:31232
  s_add_u32 m0, s98, 65536
  s_add_u32 s62, s100, 393216
  buffer_load_dwordx4 v8, s[44:47], s62 offen lds
  s_waitcnt lgkmcnt(10)
  v_mfma_f32_32x32x16_bf16 v[32:47], v[60:63], a[84:87], v[32:47]
  s_add_u32 m0, s98, 73728
  s_add_u32 s62, s100, 589824
  buffer_load_dwordx4 v8, s[44:47], s62 offen lds
  s_cmp_lg_u32 s4, 0
  s_cbranch_scc1 B_NOZL
  v_lshlrev_b32 v4, 5, v1
  s_mov_b64 exec, 0xff
  global_load_dword v127, v4, s[34:35] sc1
  s_mov_b64 exec, -1
B_NOZL:
  s_waitcnt vmcnt(8) lgkmcnt(0)
  s_barrier
  v_mfma_f32_32x32x16_bf16 v[16:31], v[64:67], a[88:91], v[16:31]
  ds_read_b128 a[96:99], v10 offset:32768
  ds_read_b64_tr_b16 v[48:49], v14 offset:32768
  ds_read_b64_tr_b16 v[50:51], v14 offset:33280
  v_mfma_f32_32x32x16_bf16 v[32:47], v[68:71], a[88:91], v[32:47]
  ds_read_b64_tr_b16 v[52:53], v14 offset:40960
  ds_read_b64_tr_b16 v[54:55], v14 offset:41472
  ds_read_b128 a[100:103], v11 offset:32768
  v_mfma_f32_32x32x16_bf16 v[16:31], v[72:75], a[92:95], v[16:31]
  ds_read_b64_tr_b16 v[56:57], v14 offset:34816
  ds_read_b64_tr_b16 v[58:59], v14 offset:35328
  ds_read_b64_tr_b16 v[60:61], v14 offset:43008
  s_add_u32 m0, s98, 16384
  s_add_u32 s62, s100, 786432
  buffer_load_dwordx4 v8, s[44:47], s62 offen lds
  v_mfma_f32_32x32x16_bf16 v[32:47], v[76:79], a[92:95], v[32:47]
  ds_read_b64_tr_b16 v[62:63], v14 offset:43520
  ds_read_b128 a[104:107], v12 offset:32768
  ds_read_b64_tr_b16 v[64:65], v14 offset:36864
  s_cmp_lg_u32 s19, 10
  s_cbranch_scc1 B_NG5_0
  v_mfma_f32_32x32x16_bf16 v[88:103], v[112:115], a[80:83], 0
  v_mfma_f32_32x32x16_bf16 v[88:103], v[116:119], a[84:87], v[88:103]
B_NG5_0:
  s_cmp_lg_u32 s19, 11
  s_cbranch_scc1 B_NG5_1
  v_mfma_f32_32x32x16_bf16 v[88:103], v[112:115], a[88:91], 0
  v_mfma_f32_32x32x16_bf16 v[88:103], v[116:119], a[92:95], v[88:103]
B_NG5_1:
  s_waitcnt lgkmcnt(9)
  v_mfma_f32_32x32x16_bf16 v[16:31], v[48:51], a[96:99], v[16:31]
  ds_read_b64_tr_b16 v[66:67], v14 offset:37376
  ds_read_b64_tr_b16 v[68:69], v14 offset:45056
  ds_read_b64_tr_b16 v[70:71], v14 offset:45568
  s_add_u32 m0, s98, 24576
  s_add_u32 s62, s100, 983040
  buffer_load_dwordx4 v8, s[44:47], s62 offen lds
  s_waitcnt lgkmcnt(10)
  v_mfma_f32_32x32x16_bf16 v[32:47], v[52:55], a[96:99], v[32:47]
  ds_read_b128 a[108:111], v13 offset:32768
  ds_read_b64_tr_b16 v[72:73], v14 offset:38912
  ds_read_b64_tr_b16 v[74:75], v14 offset:39424
  s_waitcnt lgkmcnt(10)
  v_mfma_f32_32x32x16_bf16 v[16:31], v[56:59], a[100:103], v[16:31]
  ds_read_b64_tr_b16 v[76:77], v14 offset:47104
  ds_read_b64_tr_b16 v[78:79], v14 offset:47616
  s_add_u32 m0, s98, 81920
  s_add_u32 s62, s100, 1179648
  buffer_load_dwordx4 v8, s[44:47], s62 offen lds
  s_waitcnt lgkmcnt(10)
  v_mfma_f32_32x32x16_bf16 v[32:47], v[60:63], a[100:103], v[32:47]
  s_add_u32 m0, s98, 90112
  s_add_u32 s62, s100, 1376256
  buffer_load_dwordx4 v8, s[44:47], s62 offen lds
  s_waitcnt vmcnt(8) lgkmcnt(0)
  s_barrier
  v_mfma_f32_32x32x16_bf16 v[16:31], v[64:67], a[104:107], v[16:31]
  ds_read_b128 a[112:115], v10 offset:49152
  ds_read_b64_tr_b16 v[48:49], v14 offset:49152
  ds_read_b64_tr_b16 v[50:51], v14 offset:49664
  v_mfma_f32_32x32x16_bf16 v[32:47], v[68:71], a[104:107], v[32:47]
  ds_read_b64_tr_b16 v[52:53], v14 offset:57344
  ds_read_b64_tr_b16 v[54:55], v14 offset:57856
  ds_read_b128 a[116:119], v11 offset:49152
  v_mfma_f32_32x32x16_bf16 v[16:31], v[72:75], a[108:111], v[16:31]
  ds_read_b64_tr_b16 v[56:57], v14 offset:51200
  ds_read_b64_tr_b16 v[58:59], v14 offset:51712
  ds_read_b64_tr_b16 v[60:61], v14 offset:59392
  v_mfma_f32_32x32x16_bf16 v[32:47], v[76:79], a[108:111], v[32:47]
  ds_read_b64_tr_b16 v[62:63], v14 offset:59904
  ds_read_b128 a[120:123], v12 offset:49152
  ds_read_b64_tr_b16 v[64:65], v14 offset:53248
  s_cmp_lg_u32 s19, 12
  s_cbranch_scc1 B_NG6_0
  v_mfma_f32_32x32x16_bf16 v[88:103], v[112:115], a[96:99], 0
  v_mfma_f32_32x32x16_bf16 v[88:103], v[116:119], a[100:103], v[88:103]
B_NG6_0:
  s_cmp_lg_u32 s19, 13
  s_cbranch_scc1 B_NG6_1
  v_mfma_f32_32x32x16_bf16 v[88:103], v[112:115], a[104:107], 0
  v_mfma_f32_32x32x16_bf16 v[88:103], v[116:119], a[108:111], v[88:103]
B_NG6_1:
  s_waitcnt lgkmcnt(9)
  v_mfma_f32_32x32x16_bf16 v[16:31], v[48:51], a[112:115], v[16:31]
  ds_read_b64_tr_b16 v[66:67], v14 offset:53760
  ds_read_b64_tr_b16 v[68:69], v14 offset:61440
  ds_read_b64_tr_b16 v[70:71], v14 offset:61952
  s_waitcnt lgkmcnt(10)
  v_mfma_f32_32x32x16_bf16 v[32:47], v[52:55], a[112:115], v[32:47]
  ds_read_b128 a[124:127], v13 offset:49152
  ds_read_b64_tr_b16 v[72:73], v14 offset:55296
  ds_read_b64_tr_b16 v[74:75], v14 offset:55808
  s_waitcnt lgkmcnt(10)
  v_mfma_f32_32x32x16_bf16 v[16:31], v[56:59], a[116:119], v[16:31]
  ds_read_b64_tr_b16 v[76:77], v14 offset:63488
  ds_read_b64_tr_b16 v[78:79], v14 offset:64000
  s_waitcnt lgkmcnt(10)
  v_mfma_f32_32x32x16_bf16 v[32:47], v[60:63], a[116:119], v[32:47]
  s_waitcnt lgkmcnt(0)
  s_barrier
  v_mfma_f32_32x32x16_bf16 v[16:31], v[64:67], a[120:123], v[16:31]
  s_add_u32 m0, s23, 32768
  s_add_u32 s62, s22, 262144
  buffer_load_dwordx4 v9, s[52:55], s62 offen lds
  v_mfma_f32_32x32x16_bf16 v[32:47], v[68:71], a[120:123], v[32:47]
  s_add_u32 m0, s23, 33792
  s_add_u32 s62, s22, 327680
  buffer_load_dwordx4 v9, s[52:55], s62 offen lds
  v_mfma_f32_32x32x16_bf16 v[16:31], v[72:75], a[124:127], v[16:31]
  s_add_u32 m0, s23, 34816
  s_add_u32 s62, s22, 393216
  buffer_load_dwordx4 v9, s[52:55], s62 offen lds
  v_mfma_f32_32x32x16_bf16 v[32:47], v[76:79], a[124:127], v[32:47]
  s_add_u32 m0, s23, 35840
  s_add_u32 s62, s22, 458752
  buffer_load_dwordx4 v9, s[52:55], s62 offen lds
  s_cmp_lg_u32 s19, 14
  s_cbranch_scc1 B_NG7_0
  v_mfma_f32_32x32x16_bf16 v[88:103], v[112:115], a[112:115], 0
  v_mfma_f32_32x32x16_bf16 v[88:103], v[116:119], a[116:119], v[88:103]
B_NG7_0:
  s_cmp_lg_u32 s19, 15
  s_cbranch_scc1 B_NG7_1
  v_mfma_f32_32x32x16_bf16 v[88:103], v[112:115], a[120:123], 0
  v_mfma_f32_32x32x16_bf16 v[88:103], v[116:119], a[124:127], v[88:103]
B_NG7_1:
  s_nop 0
  v_cvt_pk_bf16_f32 v48, v16, v17
  v_cvt_pk_bf16_f32 v49, v18, v19
  v_cvt_pk_bf16_f32 v50, v20, v21
  v_cvt_pk_bf16_f32 v51, v22, v23
  v_cvt_pk_bf16_f32 v52, v24, v25
  v_cvt_pk_bf16_f32 v53, v26, v27
  v_cvt_pk_bf16_f32 v54, v28, v29
  v_cvt_pk_bf16_f32 v55, v30, v31
  v_mfma_f32_32x32x16_bf16 v[56:71], v[80:83], v[48:51], 0
  s_nop 0
  v_mfma_f32_32x32x16_bf16 v[56:71], v[84:87], v[52:55], v[56:71]
  v_cvt_pk_bf16_f32 v72, v32, v33
  v_cvt_pk_bf16_f32 v73, v34, v35
  v_cvt_pk_bf16_f32 v74, v36, v37
  v_cvt_pk_bf16_f32 v75, v38, v39
  v_cvt_pk_bf16_f32 v76, v40, v41
  v_cvt_pk_bf16_f32 v77, v42, v43
  v_cvt_pk_bf16_f32 v78, v44, v45
  v_cvt_pk_bf16_f32 v79, v46, v47
  ds_write_b128 v110, v[72:75]
  ds_write_b128 v110, v[76:79] offset:4096
  buffer_store_dword v88, v108, s[48:51], s18 offen sc1
  v_mov_b32 v44, 0x3f803f80
  v_mov_b32 v45, 0x3f803f80
  v_mov_b32 v46, 0x3f803f80
  v_mov_b32 v47, 0x3f803f80
  v_max3_f32 v16, v56, v57, v58
  v_min3_f32 v18, v56, v57, v58
  v_max3_f32 v17, v59, v60, v61
  v_min3_f32 v19, v59, v60, v61
  v_max3_f32 v16, v16, v62, v63
  v_min3_f32 v18, v18, v62, v63
  v_max3_f32 v17, v17, v64, v65
  v_min3_f32 v19, v19, v64, v65
  buffer_store_dwordx4 v[104:107], v121, s[48:51], s17 offen sc1
  v_max3_f32 v16, v16, v66, v67
  v_min3_f32 v18, v18, v66, v67
  v_max3_f32 v17, v17, v68, v69
  v_min3_f32 v19, v19, v68, v69
  v_max3_f32 v16, v16, v70, v71
  v_min3_f32 v18, v18, v70, v71
  v_max_f32 v16, v16, v17
  v_min_f32 v18, v18, v19
  v_mul_f32 v16, s61, v16
  v_mul_f32 v18, s60, v18
  v_pk_fma_f32 v[20:21], v[56:57], s[60:61], v[16:17] op_sel_hi:[1,0,0]
  v_pk_fma_f32 v[22:23], v[58:59], s[60:61], v[16:17] op_sel_hi:[1,0,0]
  v_pk_fma_f32 v[24:25], v[60:61], s[60:61], v[16:17] op_sel_hi:[1,0,0]
  v_pk_fma_f32 v[26:27], v[62:63], s[60:61], v[16:17] op_sel_hi:[1,0,0]
  v_pk_fma_f32 v[28:29], v[64:65], s[60:61], v[16:17] op_sel_hi:[1,0,0]
  v_pk_fma_f32 v[30:31], v[66:67], s[60:61], v[16:17] op_sel_hi:[1,0,0]
  buffer_store_dwordx4 v[104:107], v121, s[48:51], s17 offen offset:256 sc1
  v_pk_fma_f32 v[32:33], v[68:69], s[60:61], v[16:17] op_sel_hi:[1,0,0]
  v_pk_fma_f32 v[34:35], v[70:71], s[60:61], v[16:17] op_sel_hi:[1,0,0]
  v_exp_f32 v20, v20
  v_exp_f32 v21, v21
  v_exp_f32 v22, v22
  v_exp_f32 v23, v23
  v_exp_f32 v24, v24
  v_exp_f32 v25, v25
  v_exp_f32 v26, v26
  v_exp_f32 v27, v27
  v_exp_f32 v28, v28
  v_exp_f32 v29, v29
  v_exp_f32 v30, v30
  v_exp_f32 v31, v31
  v_exp_f32 v32, v32
  v_exp_f32 v33, v33
  v_exp_f32 v34, v34
  v_exp_f32 v35, v35
  v_pk_add_f32 v[88:89], v[20:21], v[22:23]
  v_pk_add_f32 v[90:91], v[24:25], v[26:27]
  v_pk_add_f32 v[92:93], v[28:29], v[30:31]
  v_pk_add_f32 v[94:95], v[32:33], v[34:35]
  v_pk_add_f32 v[88:89], v[88:89], v[90:91]
  v_pk_add_f32 v[92:93], v[92:93], v[94:95]
  v_pk_add_f32 v[88:89], v[88:89], v[92:93]
  v_add_f32 v36, v88, v89
  v_rcp_f32 v36, v36
  s_nop 0
  v_pk_mul_f32 v[20:21], v[20:21], v[36:37] op_sel_hi:[1,0]
  v_pk_mul_f32 v[22:23], v[22:23], v[36:37] op_sel_hi:[1,0]
  v_pk_mul_f32 v[24:25], v[24:25], v[36:37] op_sel_hi:[1,0]
  v_pk_mul_f32 v[26:27], v[26:27], v[36:37] op_sel_hi:[1,0]
  v_pk_mul_f32 v[28:29], v[28:29], v[36:37] op_sel_hi:[1,0]
  v_pk_mul_f32 v[30:31], v[30:31], v[36:37] op_sel_hi:[1,0]
  v_pk_mul_f32 v[32:33], v[32:33], v[36:37] op_sel_hi:[1,0]
  v_pk_mul_f32 v[34:35], v[34:35], v[36:37] op_sel_hi:[1,0]
  v_cvt_pk_bf16_f32 v88, v20, v21
  v_cvt_pk_bf16_f32 v89, v22, v23
  v_cvt_pk_bf16_f32 v90, v24, v25
  v_cvt_pk_bf16_f32 v91, v26, v27
  v_cvt_pk_bf16_f32 v92, v28, v29
  v_cvt_pk_bf16_f32 v93, v30, v31
  v_cvt_pk_bf16_f32 v94, v32, v33
  v_cvt_pk_bf16_f32 v95, v34, v35
  ds_write_b128 v111, v[88:91] offset:0
  ds_write_b128 v111, v[92:95] offset:16
  v_pk_fma_f32 v[56:57], v[56:57], s[60:61], v[18:19] op_sel:[0,1,0] op_sel_hi:[1,1,0]
  v_pk_fma_f32 v[58:59], v[58:59], s[60:61], v[18:19] op_sel:[0,1,0] op_sel_hi:[1,1,0]
  v_pk_fma_f32 v[60:61], v[60:61], s[60:61], v[18:19] op_sel:[0,1,0] op_sel_hi:[1,1,0]
  v_pk_fma_f32 v[62:63], v[62:63], s[60:61], v[18:19] op_sel:[0,1,0] op_sel_hi:[1,1,0]
  v_pk_fma_f32 v[64:65], v[64:65], s[60:61], v[18:19] op_sel:[0,1,0] op_sel_hi:[1,1,0]
  v_pk_fma_f32 v[66:67], v[66:67], s[60:61], v[18:19] op_sel:[0,1,0] op_sel_hi:[1,1,0]
  v_pk_fma_f32 v[68:69], v[68:69], s[60:61], v[18:19] op_sel:[0,1,0] op_sel_hi:[1,1,0]
  v_pk_fma_f32 v[70:71], v[70:71], s[60:61], v[18:19] op_sel:[0,1,0] op_sel_hi:[1,1,0]
  v_exp_f32 v56, v56
  v_exp_f32 v57, v57
  v_exp_f32 v58, v58
  v_exp_f32 v59, v59
  v_exp_f32 v60, v60
  v_exp_f32 v61, v61
  v_exp_f32 v62, v62
  v_exp_f32 v63, v63
  v_exp_f32 v64, v64
  v_exp_f32 v65, v65
  v_exp_f32 v66, v66
  v_exp_f32 v67, v67
  v_exp_f32 v68, v68
  v_exp_f32 v69, v69
  v_exp_f32 v70, v70
  v_exp_f32 v71, v71
  v_pk_add_f32 v[96:97], v[56:57], v[58:59]
  v_pk_add_f32 v[98:99], v[60:61], v[62:63]
  v_pk_add_f32 v[100:101], v[64:65], v[66:67]
  v_pk_add_f32 v[102:103], v[68:69], v[70:71]
  v_pk_add_f32 v[96:97], v[96:97], v[98:99]
  v_pk_add_f32 v[100:101], v[100:101], v[102:103]
  v_pk_add_f32 v[96:97], v[96:97], v[100:101]
  v_add_f32 v36, v96, v97
  v_rcp_f32 v36, v36
  s_nop 0
  v_pk_mul_f32 v[56:57], v[56:57], v[36:37] op_sel_hi:[1,0]
  v_pk_mul_f32 v[58:59], v[58:59], v[36:37] op_sel_hi:[1,0]
  v_pk_mul_f32 v[60:61], v[60:61], v[36:37] op_sel_hi:[1,0]
  v_pk_mul_f32 v[62:63], v[62:63], v[36:37] op_sel_hi:[1,0]
  v_pk_mul_f32 v[64:65], v[64:65], v[36:37] op_sel_hi:[1,0]
  v_pk_mul_f32 v[66:67], v[66:67], v[36:37] op_sel_hi:[1,0]
  v_pk_mul_f32 v[68:69], v[68:69], v[36:37] op_sel_hi:[1,0]
  v_pk_mul_f32 v[70:71], v[70:71], v[36:37] op_sel_hi:[1,0]
  v_cvt_pk_bf16_f32 v96, v56, v57
  v_cvt_pk_bf16_f32 v97, v58, v59
  v_cvt_pk_bf16_f32 v98, v60, v61
  v_cvt_pk_bf16_f32 v99, v62, v63
  v_cvt_pk_bf16_f32 v100, v64, v65
  v_cvt_pk_bf16_f32 v101, v66, v67
  v_cvt_pk_bf16_f32 v102, v68, v69
  v_cvt_pk_bf16_f32 v103, v70, v71
  ds_write_b128 v111, v[96:99] offset:4096
  ds_write_b128 v111, v[100:103] offset:4112
  s_add_u32 s21, s7, 5120
  s_cmp_lg_u32 s4, 0
  s_cbranch_scc1 B_NOZW
  s_waitcnt vmcnt(11)
  s_mov_b64 exec, 0xff
  v_cmp_ne_u32 vcc, 16, v127
  s_cbranch_vccz B_ZW_OK
  v_lshlrev_b32 v4, 5, v1
B_ZW_L:
  global_load_dword v127, v4, s[34:35] sc1
  s_waitcnt vmcnt(0)
  v_cmp_ne_u32 vcc, 16, v127
  s_cbranch_vccnz B_ZW_L
B_ZW_OK:
  s_mov_b64 exec, -1
B_NOZW:
  s_waitcnt vmcnt(0) lgkmcnt(0)
  s_barrier
  s_cmp_lg_u32 s4, 7
  s_cbranch_scc1 B_NOPS
  s_and_b32 s62, s2, 7
  s_lshl_b32 s62, s62, 5
  v_mov_b32 v4, s62
  v_mov_b32 v5, 1
  s_mov_b64 exec, 1
  global_atomic_add v4, v5, s[34:35] offset:4 sc1
  s_mov_b64 exec, -1
B_NOPS:
  s_setprio 3
  ds_read_b64_tr_b16 v[48:49], v124 offset:0
  ds_read_b64_tr_b16 v[50:51], v124 offset:512
  ds_read_b64_tr_b16 v[64:65], v125 offset:0
  ds_read_b64_tr_b16 v[66:67], v125 offset:512
  ds_read_b64_tr_b16 v[52:53], v124 offset:1024
  ds_read_b64_tr_b16 v[54:55], v124 offset:1536
  ds_read_b64_tr_b16 v[68:69], v125 offset:1024
  ds_read_b64_tr_b16 v[70:71], v125 offset:1536
  ds_read_b64_tr_b16 v[56:57], v124 offset:2048
  ds_read_b64_tr_b16 v[58:59], v124 offset:2560
  ds_read_b64_tr_b16 v[72:73], v125 offset:2048
  ds_read_b64_tr_b16 v[74:75], v125 offset:2560
  ds_read_b64_tr_b16 v[60:61], v124 offset:3072
  ds_read_b64_tr_b16 v[62:63], v124 offset:3584
  ds_read_b64_tr_b16 v[76:77], v125 offset:3072
  ds_read_b64_tr_b16 v[78:79], v125 offset:3584
  s_waitcnt lgkmcnt(12)
  v_mfma_f32_16x16x32_bf16 v[16:19], v[48:51], v[64:67], 0
  v_mfma_f32_16x16x32_bf16 v[20:23], v[44:47], v[48:51], 0
  s_waitcnt lgkmcnt(8)
  v_mfma_f32_16x16x32_bf16 v[16:19], v[52:55], v[68:71], v[16:19]
  v_mfma_f32_16x16x32_bf16 v[20:23], v[44:47], v[52:55], v[20:23]
  s_waitcnt lgkmcnt(4)
  v_mfma_f32_16x16x32_bf16 v[16:19], v[56:59], v[72:75], v[16:19]
  v_mfma_f32_16x16x32_bf16 v[20:23], v[44:47], v[56:59], v[20:23]
  s_waitcnt lgkmcnt(0)
  v_mfma_f32_16x16x32_bf16 v[16:19], v[60:63], v[76:79], v[16:19]
  v_mfma_f32_16x16x32_bf16 v[20:23], v[44:47], v[60:63], v[20:23]
  ds_read_b64_tr_b16 v[48:49], v15 offset:0
  ds_read_b64_tr_b16 v[50:51], v15 offset:512
  ds_read_b64_tr_b16 v[52:53], v15 offset:2048
  ds_read_b64_tr_b16 v[54:55], v15 offset:2560
  ds_read_b64_tr_b16 v[56:57], v15 offset:4096
  ds_read_b64_tr_b16 v[58:59], v15 offset:4608
  ds_read_b64_tr_b16 v[60:61], v15 offset:6144
  ds_read_b64_tr_b16 v[62:63], v15 offset:6656
  v_cvt_pk_bf16_f32 v40, v16, v17
  v_cvt_pk_bf16_f32 v41, v18, v19
  v_cvt_pk_bf16_f32 v42, v16, v17
  v_cvt_pk_bf16_f32 v43, v18, v19
  v_min_u32 v20, -2, v20
  v_permlane16_swap_b32 v40, v42
  v_permlane16_swap_b32 v41, v43
  v_min_u32 v40, -2, v40
  buffer_store_dword v20, v123, s[48:51], s3 offen offset:512 sc1
  buffer_store_dwordx4 v[40:43], v122, s[48:51], s3 offen sc1
  s_setprio 0
  ds_read_b64_tr_b16 v[64:65], v15 offset:8192
  ds_read_b64_tr_b16 v[66:67], v15 offset:8704
  ds_read_b64_tr_b16 v[68:69], v15 offset:10240
  ds_read_b64_tr_b16 v[70:71], v15 offset:10752
  s_waitcnt lgkmcnt(10)
  v_mfma_f32_32x32x16_bf16 v[24:39], v[48:51], a[0:3], 0
  v_and_b32 v4, 15, v1
  v_lshrrev_b32 v5, 4, v1
  v_mul_u32_u24 v105, 640, v5
  v_lshl_add_u32 v105, v4, 2, v105
  ds_read_b64_tr_b16 v[48:49], v15 offset:12288
  ds_read_b64_tr_b16 v[50:51], v15 offset:12800
  s_waitcnt lgkmcnt(10)
  v_mfma_f32_32x32x16_bf16 v[24:39], v[52:55], a[4:7], v[24:39]
  v_add_u32 v105, 512, v105
  s_lshl_b32 s64, s4, 9
  s_add_u32 s64, s64, 114688
  v_lshl_add_u32 v106, v4, 5, s64
  ds_read_b64_tr_b16 v[52:53], v15 offset:14336
  ds_read_b64_tr_b16 v[54:55], v15 offset:14848
  s_waitcnt lgkmcnt(10)
  v_mfma_f32_32x32x16_bf16 v[24:39], v[56:59], a[8:11], v[24:39]
  v_lshl_add_u32 v106, v5, 3, v106
  s_lshl_b32 s64, s4, 5
  s_add_u32 s64, s64, 118784
  v_lshl_add_u32 v107, v4, 1, s64
  ds_read_b64_tr_b16 v[56:57], v14 offset:0
  ds_read_b64_tr_b16 v[58:59], v14 offset:512
  s_waitcnt lgkmcnt(10)
  v_mfma_f32_32x32x16_bf16 v[24:39], v[60:63], a[12:15], v[24:39]
  v_mul_u32_u24 v104, 640, v3
  v_lshl_add_u32 v104, v4, 5, v104
  v_and_b32 v4, 16, v1
  v_add_u32 v104, v4, v104
  ds_read_b64_tr_b16 v[60:61], v14 offset:2048
  ds_read_b64_tr_b16 v[62:63], v14 offset:2560
  s_waitcnt lgkmcnt(10)
  v_mfma_f32_32x32x16_bf16 v[24:39], v[64:67], a[16:19], v[24:39]
  v_bfe_u32 v4, v1, 2, 2
  v_cmp_eq_u32 vcc, v5, v4
  s_lshl_b32 s64, s101, 7
  s_add_u32 s64, s64, 118784
  ds_read_b64_tr_b16 v[64:65], v14 offset:4096
  ds_read_b64_tr_b16 v[66:67], v14 offset:4608
  s_waitcnt lgkmcnt(10)
  v_mfma_f32_32x32x16_bf16 v[24:39], v[68:71], a[20:23], v[24:39]
  v_lshl_add_u32 v4, v3, 6, s64
  v_mov_b32 v110, 119808
  v_cndmask_b32 v111, v110, v4, vcc
  v_and_b32 v4, 3, v1
  ds_read_b64_tr_b16 v[68:69], v14 offset:6144
  ds_read_b64_tr_b16 v[70:71], v14 offset:6656
  s_waitcnt lgkmcnt(10)
  v_mfma_f32_32x32x16_bf16 v[24:39], v[48:51], a[24:27], v[24:39]
  v_lshlrev_b32 v109, 7, v4
  v_bfe_u32 v4, v1, 3, 1
  v_lshl_add_u32 v109, v4, 6, v109
  v_bfe_u32 v5, v1, 4, 1
  ds_read_b64_tr_b16 v[48:49], v14 offset:8192
  ds_read_b64_tr_b16 v[50:51], v14 offset:8704
  s_waitcnt lgkmcnt(10)
  v_mfma_f32_32x32x16_bf16 v[24:39], v[52:55], a[28:31], v[24:39]
  v_lshl_add_u32 v109, v5, 5, v109
  v_lshl_add_u32 v109, v3, 10, v109
  s_lshl_b32 s64, s101, 11
  s_add_u32 s64, s64, 114688
  ds_read_b64_tr_b16 v[52:53], v14 offset:10240
  ds_read_b64_tr_b16 v[54:55], v14 offset:10752
  s_waitcnt lgkmcnt(10)
  v_mfma_f32_32x32x16_bf16 v[24:39], v[56:59], a[32:35], v[24:39]
  v_add_u32 v109, s64, v109
  v_bfe_u32 v10, v1, 2, 1
  v_cmp_eq_u32 vcc, v10, v3
  s_nop 1
  v_cndmask_b32 v109, v110, v109, vcc
  ds_read_b64_tr_b16 v[56:57], v14 offset:12288
  ds_read_b64_tr_b16 v[58:59], v14 offset:12800
  s_waitcnt lgkmcnt(10)
  v_mfma_f32_32x32x16_bf16 v[24:39], v[60:63], a[36:39], v[24:39]
  v_mov_b32 v72, 0
  v_mov_b32 v73, 0
  v_mov_b32 v74, 0
  v_mov_b32 v75, 0
  ds_read_b64_tr_b16 v[60:61], v14 offset:14336
  ds_read_b64_tr_b16 v[62:63], v14 offset:14848
  s_waitcnt lgkmcnt(10)
  v_mfma_f32_32x32x16_bf16 v[24:39], v[64:67], a[40:43], v[24:39]
  v_lshl_add_u32 v110, v1, 4, v110
  ds_write_b128 v110, v[72:75]
  v_cmp_eq_u32 vcc, v4, v5
  v_bfe_u32 v4, v1, 1, 2
  ds_read_b64_tr_b16 v[64:65], v15 offset:16384
  ds_read_b64_tr_b16 v[66:67], v15 offset:16896
  s_waitcnt lgkmcnt(11)
  v_mfma_f32_32x32x16_bf16 v[24:39], v[68:71], a[44:47], v[24:39]
  v_cndmask_b32 v4, 7, v4, vcc
  v_and_b32 v5, 1, v1
  v_lshlrev_b32 v5, 4, v5
  v_mov_b32 v110, 0x3f80
  ds_read_b64_tr_b16 v[68:69], v15 offset:18432
  ds_read_b64_tr_b16 v[70:71], v15 offset:18944
  s_waitcnt lgkmcnt(11)
  v_mfma_f32_32x32x16_bf16 v[24:39], v[48:51], a[48:51], v[24:39]
  v_lshlrev_b32 v5, v5, v110
  v_cmp_eq_u32 vcc, 0, v4
  s_nop 1
  v_cndmask_b32 v10, 0, v5, vcc
  v_cmp_eq_u32 vcc, 1, v4
  ds_read_b64_tr_b16 v[48:49], v15 offset:20480
  ds_read_b64_tr_b16 v[50:51], v15 offset:20992
  s_waitcnt lgkmcnt(11)
  v_mfma_f32_32x32x16_bf16 v[24:39], v[52:55], a[52:55], v[24:39]
  v_cndmask_b32 v11, 0, v5, vcc
  v_cmp_eq_u32 vcc, 2, v4
  s_nop 1
  v_cndmask_b32 v12, 0, v5, vcc
  v_cmp_eq_u32 vcc, 3, v4
  ds_read_b64_tr_b16 v[52:53], v15 offset:22528
  ds_read_b64_tr_b16 v[54:55], v15 offset:23040
  s_waitcnt lgkmcnt(11)
  v_mfma_f32_32x32x16_bf16 v[24:39], v[56:59], a[56:59], v[24:39]
  v_cndmask_b32 v13, 0, v5, vcc
  v_mov_b32 v110, 1.0
  v_bfe_u32 v4, v1, 2, 1
  v_and_b32 v5, 3, v1
  ds_read_b64_tr_b16 v[56:57], v15 offset:24576
  ds_read_b64_tr_b16 v[58:59], v15 offset:25088
  s_waitcnt lgkmcnt(11)
  v_mfma_f32_32x32x16_bf16 v[24:39], v[60:63], a[60:63], v[24:39]
  v_lshlrev_b32 v112, 3, v5
  v_mul_u32_u24 v4, 4128, v4
  v_add_u32 v112, v4, v112
  v_mov_b32 v117, 7936
  ds_read_b64_tr_b16 v[60:61], v15 offset:26624
  ds_read_b64_tr_b16 v[62:63], v15 offset:27136
  s_waitcnt lgkmcnt(10)
  v_mfma_f32_32x32x16_bf16 v[24:39], v[64:67], a[64:67], v[24:39]
  v_lshrrev_b32 v4, 4, v1
  v_and_b32 v5, 15, v1
  v_lshlrev_b32 v118, 3, v5
  v_lshl_add_u32 v118, v4, 14, v118
  buffer_load_dwordx4 a[0:3], v104, s[48:51], s7 offen sc1
  ds_read_b64_tr_b16 v[64:65], v15 offset:28672
  ds_read_b64_tr_b16 v[66:67], v15 offset:29184
  s_waitcnt lgkmcnt(10)
  v_mfma_f32_32x32x16_bf16 v[24:39], v[68:71], a[68:71], v[24:39]
  v_lshlrev_b32 v119, 2, v5
  v_lshl_add_u32 v119, v4, 9, v119
  v_lshlrev_b32 v120, 10, v5
  v_lshrrev_b32 v5, 1, v4
  buffer_load_dwordx4 a[4:7], v104, s[48:51], s7 offen offset:1280 sc1
  buffer_load_dword v6, v105, s[48:51], s7 offen sc1
  ds_read_b64_tr_b16 v[68:69], v15 offset:30720
  ds_read_b64_tr_b16 v[70:71], v15 offset:31232
  s_waitcnt lgkmcnt(10)
  v_mfma_f32_32x32x16_bf16 v[24:39], v[48:51], a[72:75], v[24:39]
  v_lshl_add_u32 v120, v5, 4, v120
  v_lshl_add_u32 v112, v5, 13, v112
  v_and_b32 v4, 1, v4
  v_lshl_add_u32 v120, v4, 5, v120
  s_add_u32 m0, s23, 131072
  s_add_u32 s63, s22, 0
  buffer_load_dwordx4 v9, s[52:55], s63 offen lds
  ds_read_b64_tr_b16 v[48:49], v14 offset:16384
  ds_read_b64_tr_b16 v[50:51], v14 offset:16896
  s_waitcnt lgkmcnt(10)
  v_mfma_f32_32x32x16_bf16 v[24:39], v[52:55], a[76:79], v[24:39]
  v_lshl_add_u32 v112, v4, 7, v112
  v_bfe_u32 v5, v1, 3, 1
  v_lshl_add_u32 v112, v5, 9, v112
  s_lshr_b32 s64, s4, 2
  buffer_load_dwordx4 a[8:11], v104, s[48:51], s7 offen offset:2560 sc1
  ds_read_b64_tr_b16 v[52:53], v14 offset:18432
  ds_read_b64_tr_b16 v[54:55], v14 offset:18944
  s_waitcnt lgkmcnt(10)
  v_mfma_f32_32x32x16_bf16 v[24:39], v[56:59], a[80:83], v[24:39]
  s_xor_b32 s62, s64, 1
  v_xor_b32 v5, s62, v5
  v_lshl_add_u32 v112, v5, 6, v112
  s_mul_i32 s62, s64, 0xfffe8000
  buffer_load_dwordx4 a[12:15], v104, s[48:51], s7 offen offset:3840 sc1
  buffer_load_dword v7, v105, s[48:51], s7 offen offset:2560 sc1
  ds_read_b64_tr_b16 v[56:57], v14 offset:20480
  ds_read_b64_tr_b16 v[58:59], v14 offset:20992
  s_waitcnt lgkmcnt(10)
  v_mfma_f32_32x32x16_bf16 v[24:39], v[60:63], a[84:87], v[24:39]
  s_add_u32 s62, s62, 131072
  v_add_u32 v112, s62, v112
  v_xor_b32 v113, 32, v112
  v_xor_b32 v114, 64, v112
  s_add_u32 m0, s23, 132096
  s_add_u32 s63, s22, 65536
  buffer_load_dwordx4 v9, s[52:55], s63 offen lds
  ds_read_b64_tr_b16 v[60:61], v14 offset:22528
  ds_read_b64_tr_b16 v[62:63], v14 offset:23040
  s_waitcnt lgkmcnt(10)
  v_mfma_f32_32x32x16_bf16 v[24:39], v[64:67], a[88:91], v[24:39]
  v_xor_b32 v115, 96, v112
  v_lshlrev_b32 v116, 4, v1
  s_lshl_b32 s62, s4, 11
  s_add_u32 s62, s62, 65536
  buffer_load_dwordx4 a[16:19], v104, s[48:51], s21 offen sc1
  ds_read_b64_tr_b16 v[64:65], v14 offset:24576
  ds_read_b64_tr_b16 v[66:67], v14 offset:25088
  s_waitcnt lgkmcnt(10)
  v_mfma_f32_32x32x16_bf16 v[24:39], v[68:71], a[92:95], v[24:39]
  v_add_u32 v122, s62, v116
  v_xor_b32 v123, 8192, v122
  v_lshlrev_b32 v124, 5, v1
  buffer_load_dwordx4 a[20:23], v104, s[48:51], s21 offen offset:1280 sc1
  buffer_load_dword v8, v105, s[48:51], s21 offen sc1
  ds_read_b64_tr_b16 v[68:69], v14 offset:26624
  ds_read_b64_tr_b16 v[70:71], v14 offset:27136
  s_waitcnt lgkmcnt(10)
  v_mfma_f32_32x32x16_bf16 v[24:39], v[48:51], a[96:99], v[24:39]
  s_add_u32 m0, s23, 133120
  s_add_u32 s63, s22, 131072
  buffer_load_dwordx4 v9, s[52:55], s63 offen lds
  ds_read_b64_tr_b16 v[48:49], v14 offset:28672
  ds_read_b64_tr_b16 v[50:51], v14 offset:29184
  s_waitcnt lgkmcnt(10)
  v_mfma_f32_32x32x16_bf16 v[24:39], v[52:55], a[100:103], v[24:39]
  buffer_load_dwordx4 a[24:27], v104, s[48:51], s21 offen offset:2560 sc1
  ds_read_b64_tr_b16 v[52:53], v14 offset:30720
  ds_read_b64_tr_b16 v[54:55], v14 offset:31232
  s_waitcnt lgkmcnt(10)
  v_mfma_f32_32x32x16_bf16 v[24:39], v[56:59], a[104:107], v[24:39]
  buffer_load_dwordx4 a[28:31], v104, s[48:51], s21 offen offset:3840 sc1
  buffer_load_dword v44, v105, s[48:51], s21 offen offset:2560 sc1
  s_waitcnt lgkmcnt(8)
  v_mfma_f32_32x32x16_bf16 v[24:39], v[60:63], a[108:111], v[24:39]
  s_add_u32 m0, s23, 134144
  s_add_u32 s63, s22, 196608
  buffer_load_dwordx4 v9, s[52:55], s63 offen lds
  s_waitcnt lgkmcnt(6)
  v_mfma_f32_32x32x16_bf16 v[24:39], v[64:67], a[112:115], v[24:39]
  s_waitcnt lgkmcnt(4)
  v_mfma_f32_32x32x16_bf16 v[24:39], v[68:71], a[116:119], v[24:39]
  s_waitcnt lgkmcnt(2)
  v_mfma_f32_32x32x16_bf16 v[24:39], v[48:51], a[120:123], v[24:39]
  s_waitcnt lgkmcnt(0)
  v_mfma_f32_32x32x16_bf16 v[24:39], v[52:55], a[124:127], v[24:39]
  s_nop 11
  v_cvt_pk_bf16_f32 v48, v24, v25
  v_cvt_pk_bf16_f32 v49, v26, v27
  v_cvt_pk_bf16_f32 v50, v28, v29
  v_cvt_pk_bf16_f32 v51, v30, v31
  v_cvt_pk_bf16_f32 v52, v32, v33
  v_cvt_pk_bf16_f32 v53, v34, v35
  v_cvt_pk_bf16_f32 v54, v36, v37
  v_cvt_pk_bf16_f32 v55, v38, v39
  v_mfma_f32_32x32x16_bf16 v[56:71], v[80:83], v[48:51], 0
  s_nop 0
  v_mfma_f32_32x32x16_bf16 v[56:71], v[84:87], v[52:55], v[56:71]
  s_nop 11
  v_max3_f32 v16, v56, v57, v58
  v_min3_f32 v18, v56, v57, v58
  v_max3_f32 v17, v59, v60, v61
  v_min3_f32 v19, v59, v60, v61
  v_max3_f32 v16, v16, v62, v63
  v_min3_f32 v18, v18, v62, v63
  v_max3_f32 v17, v17, v64, v65
  v_min3_f32 v19, v19, v64, v65
  v_max3_f32 v16, v16, v66, v67
  v_min3_f32 v18, v18, v66, v67
  v_max3_f32 v17, v17, v68, v69
  v_min3_f32 v19, v19, v68, v69
  v_max3_f32 v16, v16, v70, v71
  v_min3_f32 v18, v18, v70, v71
  v_max_f32 v16, v16, v17
  v_min_f32 v18, v18, v19
  v_mul_f32 v16, s61, v16
  v_mul_f32 v18, s60, v18
  v_pk_fma_f32 v[20:21], v[56:57], s[60:61], v[16:17] op_sel_hi:[1,0,0]
  v_pk_fma_f32 v[22:23], v[58:59], s[60:61], v[16:17] op_sel_hi:[1,0,0]
  v_pk_fma_f32 v[24:25], v[60:61], s[60:61], v[16:17] op_sel_hi:[1,0,0]
  v_pk_fma_f32 v[26:27], v[62:63], s[60:61], v[16:17] op_sel_hi:[1,0,0]
  v_pk_fma_f32 v[28:29], v[64:65], s[60:61], v[16:17] op_sel_hi:[1,0,0]
  v_pk_fma_f32 v[30:31], v[66:67], s[60:61], v[16:17] op_sel_hi:[1,0,0]
  v_pk_fma_f32 v[32:33], v[68:69], s[60:61], v[16:17] op_sel_hi:[1,0,0]
  v_pk_fma_f32 v[34:35], v[70:71], s[60:61], v[16:17] op_sel_hi:[1,0,0]
  v_exp_f32 v20, v20
  v_exp_f32 v21, v21
  v_exp_f32 v22, v22
  v_exp_f32 v23, v23
  v_exp_f32 v24, v24
  v_exp_f32 v25, v25
  v_exp_f32 v26, v26
  v_exp_f32 v27, v27
  v_exp_f32 v28, v28
  v_exp_f32 v29, v29
  v_exp_f32 v30, v30
  v_exp_f32 v31, v31
  v_exp_f32 v32, v32
  v_exp_f32 v33, v33
  v_exp_f32 v34, v34
  v_exp_f32 v35, v35
  v_pk_add_f32 v[88:89], v[20:21], v[22:23]
  v_pk_add_f32 v[90:91], v[24:25], v[26:27]
  v_pk_add_f32 v[92:93], v[28:29], v[30:31]
  v_pk_add_f32 v[94:95], v[32:33], v[34:35]
  v_pk_add_f32 v[88:89], v[88:89], v[90:91]
  v_pk_add_f32 v[92:93], v[92:93], v[94:95]
  v_pk_add_f32 v[88:89], v[88:89], v[92:93]
  v_add_f32 v36, v88, v89
  v_rcp_f32 v36, v36
  s_nop 0
  v_pk_mul_f32 v[20:21], v[20:21], v[36:37] op_sel_hi:[1,0]
  v_pk_mul_f32 v[22:23], v[22:23], v[36:37] op_sel_hi:[1,0]
  v_pk_mul_f32 v[24:25], v[24:25], v[36:37] op_sel_hi:[1,0]
  v_pk_mul_f32 v[26:27], v[26:27], v[36:37] op_sel_hi:[1,0]
  v_pk_mul_f32 v[28:29], v[28:29], v[36:37] op_sel_hi:[1,0]
  v_pk_mul_f32 v[30:31], v[30:31], v[36:37] op_sel_hi:[1,0]
  v_pk_mul_f32 v[32:33], v[32:33], v[36:37] op_sel_hi:[1,0]
  v_pk_mul_f32 v[34:35], v[34:35], v[36:37] op_sel_hi:[1,0]
  v_cvt_pk_bf16_f32 v88, v20, v21
  v_cvt_pk_bf16_f32 v89, v22, v23
  v_cvt_pk_bf16_f32 v90, v24, v25
  v_cvt_pk_bf16_f32 v91, v26, v27
  v_cvt_pk_bf16_f32 v92, v28, v29
  v_cvt_pk_bf16_f32 v93, v30, v31
  v_cvt_pk_bf16_f32 v94, v32, v33
  v_cvt_pk_bf16_f32 v95, v34, v35
  v_pk_fma_f32 v[56:57], v[56:57], s[60:61], v[18:19] op_sel:[0,1,0] op_sel_hi:[1,1,0]
  v_pk_fma_f32 v[58:59], v[58:59], s[60:61], v[18:19] op_sel:[0,1,0] op_sel_hi:[1,1,0]
  v_pk_fma_f32 v[60:61], v[60:61], s[60:61], v[18:19] op_sel:[0,1,0] op_sel_hi:[1,1,0]
  v_pk_fma_f32 v[62:63], v[62:63], s[60:61], v[18:19] op_sel:[0,1,0] op_sel_hi:[1,1,0]
  v_pk_fma_f32 v[64:65], v[64:65], s[60:61], v[18:19] op_sel:[0,1,0] op_sel_hi:[1,1,0]
  v_pk_fma_f32 v[66:67], v[66:67], s[60:61], v[18:19] op_sel:[0,1,0] op_sel_hi:[1,1,0]
  v_pk_fma_f32 v[68:69], v[68:69], s[60:61], v[18:19] op_sel:[0,1,0] op_sel_hi:[1,1,0]
  v_pk_fma_f32 v[70:71], v[70:71], s[60:61], v[18:19] op_sel:[0,1,0] op_sel_hi:[1,1,0]
  v_exp_f32 v56, v56
  v_exp_f32 v57, v57
  v_exp_f32 v58, v58
  v_exp_f32 v59, v59
  v_exp_f32 v60, v60
  v_exp_f32 v61, v61
  v_exp_f32 v62, v62
  v_exp_f32 v63, v63
  v_exp_f32 v64, v64
  v_exp_f32 v65, v65
  v_exp_f32 v66, v66
  v_exp_f32 v67, v67
  v_exp_f32 v68, v68
  v_exp_f32 v69, v69
  v_exp_f32 v70, v70
  v_exp_f32 v71, v71
  v_pk_add_f32 v[96:97], v[56:57], v[58:59]
  v_pk_add_f32 v[98:99], v[60:61], v[62:63]
  v_pk_add_f32 v[100:101], v[64:65], v[66:67]
  v_pk_add_f32 v[102:103], v[68:69], v[70:71]
  v_pk_add_f32 v[96:97], v[96:97], v[98:99]
  v_pk_add_f32 v[100:101], v[100:101], v[102:103]
  v_pk_add_f32 v[96:97], v[96:97], v[100:101]
  v_add_f32 v36, v96, v97
  v_rcp_f32 v36, v36
  s_waitcnt vmcnt(9)
  v_add_f32 v76, v6, v7
  v_pk_mul_f32 v[56:57], v[56:57], v[36:37] op_sel_hi:[1,0]
  s_waitcnt vmcnt(1)
  v_add_f32 v77, v8, v44
  v_pk_mul_f32 v[58:59], v[58:59], v[36:37] op_sel_hi:[1,0]
  v_add_f32 v76, v76, v77
  v_pk_mul_f32 v[60:61], v[60:61], v[36:37] op_sel_hi:[1,0]
  s_nop 0
  v_mfma_f32_16x16x4_f32 v[72:75], v110, v76, 0
  v_pk_mul_f32 v[62:63], v[62:63], v[36:37] op_sel_hi:[1,0]
  v_mfma_f32_16x16x32_bf16 v[40:43], v[10:13], a[0:3], 0
  v_pk_mul_f32 v[64:65], v[64:65], v[36:37] op_sel_hi:[1,0]
  v_mfma_f32_16x16x32_bf16 v[40:43], v[10:13], a[4:7], v[40:43]
  v_pk_mul_f32 v[66:67], v[66:67], v[36:37] op_sel_hi:[1,0]
  v_mfma_f32_16x16x32_bf16 v[40:43], v[10:13], a[8:11], v[40:43]
  v_pk_mul_f32 v[68:69], v[68:69], v[36:37] op_sel_hi:[1,0]
  v_mfma_f32_16x16x32_bf16 v[40:43], v[10:13], a[12:15], v[40:43]
  v_pk_mul_f32 v[70:71], v[70:71], v[36:37] op_sel_hi:[1,0]
  v_mfma_f32_16x16x32_bf16 v[40:43], v[10:13], a[16:19], v[40:43]
  v_cvt_pk_bf16_f32 v96, v56, v57
  v_mfma_f32_16x16x32_bf16 v[40:43], v[10:13], a[20:23], v[40:43]
  v_cvt_pk_bf16_f32 v97, v58, v59
  v_mfma_f32_16x16x32_bf16 v[40:43], v[10:13], a[24:27], v[40:43]
  v_cvt_pk_bf16_f32 v98, v60, v61
  v_mfma_f32_16x16x32_bf16 v[40:43], v[10:13], a[28:31], v[40:43]
  v_cvt_pk_bf16_f32 v99, v62, v63
  v_cvt_pk_bf16_f32 v100, v64, v65
  v_cvt_pk_bf16_f32 v101, v66, v67
  v_cvt_pk_bf16_f32 v102, v68, v69
  v_cvt_pk_bf16_f32 v103, v70, v71
  s_waitcnt vmcnt(0)
  v_cvt_pk_bf16_f32 v17, v72, v72
  s_nop 0
  v_cmp_u_f32 vcc, v40, v72
  v_cvt_pk_bf16_f32 v18, v40, v41
  v_cvt_pk_bf16_f32 v19, v42, v43
  s_cbranch_vccnz B_RETRY
B_GO:
  ds_write_b64 v106, v[18:19]
  ds_write_b16 v107, v17
  s_cmp_lg_u32 s4, 0
  s_cbranch_scc1 B_PCI
  s_mov_b64 exec, 0xff
  global_load_dword v125, v124, s[34:35] offset:4 sc1
  s_mov_b64 exec, -1
B_PCI:
  s_waitcnt lgkmcnt(0)
  s_barrier
  ds_read_b128 v[40:43], v109
  ds_read_b128 v[72:75], v109 offset:512
  ds_read_b128 v[44:47], v109 offset:16
  ds_read_b128 v[76:79], v109 offset:528
  ds_read_b128 v[24:27], v111
  ds_read_b128 v[28:31], v111 offset:16
  ds_read_b128 v[32:35], v111 offset:32
  ds_read_b128 v[36:39], v111 offset:48
  s_waitcnt lgkmcnt(7)
  v_mfma_f32_32x32x16_bf16 v[8:23], v[40:43], v[88:91], 0
  s_waitcnt lgkmcnt(6)
  v_mfma_f32_32x32x16_bf16 v[8:23], v[72:75], v[96:99], v[8:23]
  s_waitcnt lgkmcnt(3)
  v_mfma_f32_16x16x32_bf16 v[64:67], v[24:27], v[88:91], 0
  s_waitcnt lgkmcnt(2)
  v_mfma_f32_16x16x32_bf16 v[64:67], v[28:31], v[92:95], v[64:67]
  s_waitcnt lgkmcnt(1)
  v_mfma_f32_16x16x32_bf16 v[64:67], v[32:35], v[96:99], v[64:67]
  s_waitcnt lgkmcnt(0)
  v_mfma_f32_16x16x32_bf16 v[64:67], v[36:39], v[100:103], v[64:67]
  v_mfma_f32_32x32x16_bf16 v[8:23], v[44:47], v[92:95], v[8:23]
  v_mfma_f32_32x32x16_bf16 v[8:23], v[76:79], v[100:103], v[8:23]
  s_nop 5
  v_add_f32 v64, 0x358637bd, v64
  v_rcp_f32 v64, v64
  s_nop 3
  v_pk_mul_f32 v[8:9], v[8:9], v[64:65] op_sel_hi:[1,0]
  v_cvt_pk_bf16_f32 v56, v8, v9
  v_min_u32 v56, -2, v56
  v_pk_mul_f32 v[10:11], v[10:11], v[64:65] op_sel_hi:[1,0]
  v_cvt_pk_bf16_f32 v57, v10, v11
  v_pk_mul_f32 v[12:13], v[12:13], v[64:65] op_sel_hi:[1,0]
  v_cvt_pk_bf16_f32 v58, v12, v13
  v_pk_mul_f32 v[14:15], v[14:15], v[64:65] op_sel_hi:[1,0]
  v_cvt_pk_bf16_f32 v59, v14, v15
  buffer_store_dwordx4 v[56:59], v121, s[48:51], s17 offen sc1
  v_pk_mul_f32 v[16:17], v[16:17], v[64:65] op_sel_hi:[1,0]
  v_cvt_pk_bf16_f32 v60, v16, v17
  v_min_u32 v60, -2, v60
  v_pk_mul_f32 v[18:19], v[18:19], v[64:65] op_sel_hi:[1,0]
  v_cvt_pk_bf16_f32 v61, v18, v19
  v_pk_mul_f32 v[20:21], v[20:21], v[64:65] op_sel_hi:[1,0]
  v_cvt_pk_bf16_f32 v62, v20, v21
  v_pk_mul_f32 v[22:23], v[22:23], v[64:65] op_sel_hi:[1,0]
  v_cvt_pk_bf16_f32 v63, v22, v23
  buffer_store_dwordx4 v[60:63], v121, s[48:51], s17 offen offset:256 sc1
  s_branch TAIL
B_RETRY:
  s_mov_b32 s62, 0
  v_cmp_eq_u32 vcc, -1, v6
  s_cbranch_vccz B_RSZ0
  buffer_load_dword v6, v105, s[48:51], s7 offen sc1
  s_mov_b32 s62, 1
B_RSZ0:
  v_cmp_eq_u32 vcc, -1, v7
  s_cbranch_vccz B_RSZ1
  buffer_load_dword v7, v105, s[48:51], s7 offen offset:2560 sc1
  s_mov_b32 s62, 1
B_RSZ1:
  v_cmp_eq_u32 vcc, -1, v8
  s_cbranch_vccz B_RSZ2
  buffer_load_dword v8, v105, s[48:51], s21 offen sc1
  s_mov_b32 s62, 1
B_RSZ2:
  v_cmp_eq_u32 vcc, -1, v44
  s_cbranch_vccz B_RSZ3
  buffer_load_dword v44, v105, s[48:51], s21 offen offset:2560 sc1
  s_mov_b32 s62, 1
B_RSZ3:
  v_accvgpr_read_b32 v4, a0
  v_cmp_eq_u32 vcc, -1, v4
  s_cbranch_vccz B_RSP0
  buffer_load_dwordx4 a[0:3], v104, s[48:51], s7 offen sc1
  s_mov_b32 s62, 1
B_RSP0:
  v_accvgpr_read_b32 v5, a4
  v_cmp_eq_u32 vcc, -1, v5
  s_cbranch_vccz B_RSP1
  buffer_load_dwordx4 a[4:7], v104, s[48:51], s7 offen offset:1280 sc1
  s_mov_b32 s62, 1
B_RSP1:
  v_accvgpr_read_b32 v4, a8
  v_cmp_eq_u32 vcc, -1, v4
  s_cbranch_vccz B_RSP2
  buffer_load_dwordx4 a[8:11], v104, s[48:51], s7 offen offset:2560 sc1
  s_mov_b32 s62, 1
B_RSP2:
  v_accvgpr_read_b32 v5, a12
  v_cmp_eq_u32 vcc, -1, v5
  s_cbranch_vccz B_RSP3
  buffer_load_dwordx4 a[12:15], v104, s[48:51], s7 offen offset:3840 sc1
  s_mov_b32 s62, 1
B_RSP3:
  v_accvgpr_read_b32 v4, a16
  v_cmp_eq_u32 vcc, -1, v4
  s_cbranch_vccz B_RSP4
  buffer_load_dwordx4 a[16:19], v104, s[48:51], s21 offen sc1
  s_mov_b32 s62, 1
B_RSP4:
  v_accvgpr_read_b32 v5, a20
  v_cmp_eq_u32 vcc, -1, v5
  s_cbranch_vccz B_RSP5
  buffer_load_dwordx4 a[20:23], v104, s[48:51], s21 offen offset:1280 sc1
  s_mov_b32 s62, 1
B_RSP5:
  v_accvgpr_read_b32 v4, a24
  v_cmp_eq_u32 vcc, -1, v4
  s_cbranch_vccz B_RSP6
  buffer_load_dwordx4 a[24:27], v104, s[48:51], s21 offen offset:2560 sc1
  s_mov_b32 s62, 1
B_RSP6:
  v_accvgpr_read_b32 v5, a28
  v_cmp_eq_u32 vcc, -1, v5
  s_cbranch_vccz B_RSP7
  buffer_load_dwordx4 a[28:31], v104, s[48:51], s21 offen offset:3840 sc1
  s_mov_b32 s62, 1
B_RSP7:
  s_cmp_eq_u32 s62, 0
  s_cbranch_scc1 B_GO
  s_waitcnt vmcnt(0)
  v_add_f32 v76, v6, v7
  v_add_f32 v77, v8, v44
  v_add_f32 v76, v76, v77
  s_nop 1
  v_mfma_f32_16x16x4_f32 v[72:75], v110, v76, 0
  v_mfma_f32_16x16x32_bf16 v[40:43], v[10:13], a[0:3], 0
  v_mfma_f32_16x16x32_bf16 v[40:43], v[10:13], a[4:7], v[40:43]
  v_mfma_f32_16x16x32_bf16 v[40:43], v[10:13], a[8:11], v[40:43]
  v_mfma_f32_16x16x32_bf16 v[40:43], v[10:13], a[12:15], v[40:43]
  v_mfma_f32_16x16x32_bf16 v[40:43], v[10:13], a[16:19], v[40:43]
  v_mfma_f32_16x16x32_bf16 v[40:43], v[10:13], a[20:23], v[40:43]
  v_mfma_f32_16x16x32_bf16 v[40:43], v[10:13], a[24:27], v[40:43]
  v_mfma_f32_16x16x32_bf16 v[40:43], v[10:13], a[28:31], v[40:43]
  s_nop 3
  v_cvt_pk_bf16_f32 v17, v72, v72
  s_nop 2
  v_cmp_u_f32 vcc, v40, v72
  v_cvt_pk_bf16_f32 v18, v40, v41
  v_cvt_pk_bf16_f32 v19, v42, v43
  s_cbranch_vccnz B_RETRY
  s_branch B_GO
A_ROLE:
  s_lshr_b32 s63, s2, 3
  s_and_b32 s62, s2, 7
  s_sub_u32 s63, s63, 16
  s_lshl_b32 s5, s62, 4
  s_add_u32 s5, s5, s63
  s_lshl_b32 s5, s5, 2
  s_lshr_b32 s7, s4, 1
  s_and_b32 s3, s4, 1
  s_add_u32 s6, s5, s7
  v_lshlrev_b32 v2, 1, v1
  s_lshl_b32 s62, s6, 1
  s_add_u32 s62, s62, s3
  s_lshl_b32 s62, s62, 7
  s_lshl_b32 s63, s6, 1
  v_mov_b32 v3, 0
  v_lshlrev_b32 v4, 12, v0
  s_lshl_b32 s64, s5, 1
  s_waitcnt lgkmcnt(0)
  s_mov_b32 s44, s18
  s_and_b32 s45, s19, 0xffff
  s_mov_b32 s46, 0x400
  s_mov_b32 s47, 0x20000
  buffer_load_ushort v20, v3, s[44:47], s63 offen
  s_mov_b32 s52, s10
  s_and_b32 s53, s11, 0xffff
  s_mov_b32 s54, 0x20000
  s_mov_b32 s55, 0x20000
  buffer_load_ushort v16, v2, s[52:55], s62 offen
  s_mov_b32 s56, s12
  s_and_b32 s57, s13, 0xffff
  s_mov_b32 s58, 0x20000
  s_mov_b32 s59, 0x20000
  buffer_load_ushort v17, v2, s[56:59], s62 offen
  s_mov_b32 s44, s14
  s_and_b32 s45, s15, 0xffff
  s_mov_b32 s46, 0x20000
  s_mov_b32 s47, 0x20000
  buffer_load_ushort v18, v2, s[44:47], s62 offen
  s_mov_b32 s52, s16
  s_and_b32 s53, s17, 0xffff
  s_mov_b32 s54, 0x20000
  s_mov_b32 s55, 0x20000
  buffer_load_ushort v19, v2, s[52:55], s62 offen
  s_mov_b32 s56, s20
  s_and_b32 s57, s21, 0xffff
  s_mov_b32 s58, 0x400
  s_mov_b32 s59, 0x20000
  buffer_load_ushort v21, v3, s[56:59], s63 offen
  s_lshr_b32 s64, s2, 3
  s_sub_u32 s64, s64, 16
  v_lshl_add_u32 v40, s64, 6, v1
  v_lshrrev_b32 v41, 1, v40
  v_and_b32 v42, 1, v40
  v_mul_u32_u24 v43, 3072, v41
  v_lshl_add_u32 v44, v42, 10, v43
  v_add_u32 v44, 1408, v44
  v_add_u32 v43, 384, v43
  s_and_b32 s65, s2, 6
  s_lshl_b32 s65, s65, 18
  s_add_u32 s65, s65, 384
  v_lshl_add_u32 v45, v41, 10, s65
  v_lshlrev_b32 v41, 10, v41
  v_add_u32 v41, 384, v41
  s_cmp_eq_u32 s4, 2
  s_cbranch_scc1 PF_X
  s_cmp_eq_u32 s4, 3
  s_cbranch_scc1 PF_O
  s_bitcmp1_b32 s2, 0
  s_cbranch_scc1 PF_E
  s_cmp_gt_u32 s4, 1
  s_cbranch_scc1 PF_E
  s_cmp_eq_u32 s4, 0
  s_cselect_b64 vcc, -1, 0
  v_cndmask_b32 v43, v43, v44, vcc
  global_load_dword v127, v43, s[24:25]
  s_branch PF_E
PF_X:
  global_load_dword v127, v45, s[8:9]
  s_branch PF_E
PF_O:
  global_load_dword v127, v41, s[28:29]
PF_E:
  s_lshl_b32 s64, s5, 1
  s_nop 0
  s_cmp_lt_u32 s4, 4
  s_cbranch_scc1 PF_Y
  s_lshr_b32 s62, s2, 3
  s_sub_u32 s62, s62, 16
  s_lshl_b32 s62, s62, 1
  s_bfe_u32 s63, s4, 0x10001
  s_add_u32 s62, s62, s63
  s_lshl_b32 s62, s62, 16
  s_and_b32 s63, s2, 7
  s_lshl_b32 s63, s63, 1
  s_and_b32 s65, s4, 1
  s_add_u32 s63, s63, s65
  s_lshl_b32 s63, s63, 6
  s_add_u32 s62, s62, s63
  v_lshl_add_u32 v41, v1, 10, s62
  global_load_dword v127, v41, s[8:9]
PF_Y:
  s_lshr_b32 s65, s2, 3
  s_sub_u32 s65, s65, 16
  s_cmp_gt_u32 s65, 2
  s_cbranch_scc1 IPF_X
  s_cmp_lg_u32 s4, 7
  s_cbranch_scc1 IPF_X
  s_lshl_b32 s65, s65, 13
  s_getpc_b64 s[66:67]
IPF_PC:
  s_sub_u32 s66, s66, IPF_PC-mix_f_kernel
  s_subb_u32 s67, s67, 0
  v_lshl_add_u32 v44, v1, 7, s65
  v_min_u32 v44, F_END-mix_f_kernel, v44
  v_mov_b32 v45, s67
  v_add_co_u32 v44, vcc, s66, v44
  v_addc_co_u32 v45, vcc, 0, v45, vcc
  global_load_dword v127, v[44:45], off
IPF_X:
  s_mov_b32 s40, s8
  s_and_b32 s41, s9, 0xffff
  s_mov_b32 s42, 0x200000
  s_mov_b32 s43, 0x20000
  v_mov_b32 v6, v4
  s_mov_b32 s99, s64
  s_mov_b32 s48, s36
  s_and_b32 s49, s37, 0xffff
  s_mov_b32 s50, 0x1000000
  s_mov_b32 s51, 0x20000
  v_mov_b32 v5, 0
  s_mul_i32 s62, s7, 4576
  s_mul_i32 s63, s3, 240
  s_add_u32 s62, s62, s63
  s_add_u32 s62, s62, 128704
  v_min_u32 v3, 59, v1
  v_lshl_add_u32 v3, v3, 2, s62
  ds_write_b32 v3, v5
  s_mul_i32 s62, s7, 4128
  s_add_u32 s62, s62, 142912
  v_and_b32 v3, 7, v1
  v_lshl_add_u32 v3, v3, 2, s62
  ds_write_b32 v3, v5
  s_mul_i32 s65, s7, 16896
  s_lshl_b32 s62, s3, 8
  s_add_u32 s65, s65, s62
  s_mul_i32 s98, s7, 14256
  s_add_u32 s98, s98, s62
  s_add_u32 s98, s98, 16584
  v_and_b32 v2, 15, v1
  v_lshrrev_b32 v3, 4, v1
  v_mul_u32_u24 v22, 528, v2
  v_lshl_add_u32 v22, v3, 4, v22
  s_mul_i32 s62, s7, 16896
  s_mul_i32 s63, s3, 8448
  s_add_u32 s62, s62, s63
  v_add_u32 v22, s62, v22
  s_mov_b32 s52, 0x3020100
  s_mov_b32 s53, 0xa090808
  s_mov_b32 s54, 0x130f0e0d
  s_mov_b32 s55, 0x17121110
  v_and_b32 v4, 7, v2
  v_lshlrev_b32 v4, 3, v4
  v_lshrrev_b64 v[36:37], v4, s[52:53]
  v_lshrrev_b64 v[38:39], v4, s[54:55]
  v_cmp_gt_u32 vcc, 8, v2
  buffer_load_dwordx2 v[8:9], v6, s[40:43], s99 offen
  s_nop 0
  v_cndmask_b32 v23, v38, v36, vcc
  v_and_b32 v23, 255, v23
  v_mul_u32_u24 v23, 528, v23
  v_lshl_add_u32 v23, v3, 4, v23
  s_mul_i32 s62, s7, 14256
  s_add_u32 s62, s62, 67584
  v_add_u32 v23, s62, v23
  s_mov_b32 s52, 0x7060504
  s_mov_b32 s53, 0xc0b0a0a
  s_mov_b32 s54, 0x16161514
  s_mov_b32 s55, 0x1a1a1918
  v_and_b32 v4, 7, v2
  v_lshlrev_b32 v4, 3, v4
  v_lshrrev_b64 v[36:37], v4, s[52:53]
  v_lshrrev_b64 v[38:39], v4, s[54:55]
  v_cmp_gt_u32 vcc, 8, v2
  s_nop 1
  v_cndmask_b32 v24, v38, v36, vcc
  v_and_b32 v24, 255, v24
  v_mul_u32_u24 v24, 528, v24
  v_lshl_add_u32 v24, v3, 4, v24
  s_mul_i32 s62, s7, 14256
  s_add_u32 s62, s62, 67584
  v_add_u32 v24, s62, v24
  s_mul_i32 s62, s7, 4576
  s_lshl_b32 s63, s3, 8
  s_sub_u32 s64, s62, s63
  s_add_u32 s64, s64, 128688
  v_lshlrev_b32 v4, 4, v2
  v_lshl_add_u32 v4, v3, 9, v4
  v_sub_u32 v25, s64, v4
  v_lshlrev_b32 v4, 9, v3
  v_sub_u32 v27, v25, v4
  v_subrev_u32 v27, 512, v27
  s_add_u32 s64, s62, s63
  s_add_u32 s64, s64, 125088
  v_lshlrev_b32 v4, 5, v2
  v_sub_u32 v26, s64, v4
  v_lshl_add_u32 v26, v3, 4, v26
  s_mul_i32 s62, s7, 4128
  s_add_u32 s62, s62, 142912
  buffer_load_dwordx2 v[10:11], v6, s[40:43], s99 offen offset:1024
  s_add_u32 s64, s62, s63
  v_add_u32 v4, 1, v2
  v_lshrrev_b32 v4, 1, v4
  v_lshl_add_u32 v4, v3, 2, v4
  v_lshl_add_u32 v28, v4, 2, s64
  v_add_u32 v29, 1024, v28
  v_add_u32 v30, 2048, v28
  v_add_u32 v31, 3072, v28
  v_and_b32 v32, 1, v2
  v_xor_b32 v32, 1, v32
  v_lshlrev_b32 v32, 4, v32
  v_bfe_u32 v4, v1, 1, 2
  v_xor_b32 v4, v4, v3
  v_lshlrev_b32 v4, 4, v4
  s_lshl_b32 s62, s4, 10
  s_add_u32 s62, s62, 65536
  v_lshl_add_u32 v33, v2, 6, s62
  v_add_u32 v33, v33, v4
  v_lshrrev_b32 v5, 3, v1
  v_lshl_add_u32 v4, v5, 6, v4
  v_and_b32 v5, 1, v1
  v_lshl_add_u32 v4, v5, 3, v4
  s_lshl_b32 s62, s4, 13
  s_add_u32 s62, s62, 65536
  v_add_u32 v35, s62, v4
  s_lshl_b32 s17, s5, 12
  s_lshl_b32 s62, s4, 11
  s_add_u32 s17, s17, s62
  s_and_b32 s62, s2, 7
  s_lshr_b32 s63, s2, 3
  s_lshr_b32 s39, s63, 2
  s_and_b32 s63, s63, 3
  s_lshl_b32 s38, s62, 2
  s_add_u32 s38, s38, s63
  s_lshl_b32 s22, s4, 13
  s_lshl_b32 s63, s39, 7
  s_add_u32 s22, s22, s63
  s_lshl_b32 s23, s4, 12
  s_and_b32 s62, s4, 3
  s_lshr_b32 s63, s4, 2
  buffer_load_dwordx2 v[12:13], v6, s[40:43], s99 offen offset:2048
  s_lshl_b32 s64, s38, 2
  s_add_u32 s62, s62, s64
  s_lshl_b32 s16, s62, 14
  s_lshl_b32 s64, s63, 13
  s_add_u32 s12, s16, s64
  s_add_u32 s12, s12, 0x200000
  s_add_u32 s13, s12, 4096
  s_lshl_b32 s64, s39, 1
  s_add_u32 s64, s64, s63
  s_lshl_b32 s14, s64, 17
  s_lshl_b32 s64, s64, 6
  s_add_u32 s16, s16, s64
  s_lshl_b32 s64, s62, 7
  s_add_u32 s14, s14, s64
  s_add_u32 s20, s14, 65536
  s_lshr_b32 s64, s62, 1
  s_lshl_b32 s15, s64, 11
  s_and_b32 s64, s62, 1
  s_lshl_b32 s64, s64, 6
  s_add_u32 s15, s15, s64
  s_add_u32 s15, s15, 0x520000
  v_bfe_u32 v4, v1, 2, 1
  v_and_b32 v5, 3, v1
  v_lshlrev_b32 v112, 3, v5
  v_mul_u32_u24 v4, 4128, v4
  v_add_u32 v112, v4, v112
  v_mov_b32 v117, 7936
  v_lshrrev_b32 v4, 4, v1
  v_and_b32 v5, 15, v1
  v_lshlrev_b32 v118, 3, v5
  v_lshl_add_u32 v118, v4, 14, v118
  v_lshlrev_b32 v119, 2, v5
  v_lshl_add_u32 v119, v4, 9, v119
  v_lshlrev_b32 v120, 10, v5
  v_lshrrev_b32 v5, 1, v4
  v_lshl_add_u32 v120, v5, 4, v120
  v_lshl_add_u32 v112, v5, 13, v112
  v_and_b32 v4, 1, v4
  v_lshl_add_u32 v120, v4, 5, v120
  v_lshl_add_u32 v112, v4, 7, v112
  buffer_load_dwordx2 v[14:15], v6, s[40:43], s99 offen offset:3072
  v_bfe_u32 v5, v1, 3, 1
  v_lshl_add_u32 v112, v5, 9, v112
  s_lshr_b32 s62, s4, 2
  s_xor_b32 s63, s62, 1
  v_xor_b32 v5, s63, v5
  v_lshl_add_u32 v112, v5, 6, v112
  s_mul_i32 s63, s62, 0x8000
  v_add_u32 v112, s63, v112
  v_xor_b32 v113, 32, v112
  v_xor_b32 v114, 64, v112
  v_xor_b32 v115, 96, v112
  v_lshlrev_b32 v116, 4, v1
  s_lshl_b32 s63, s4, 11
  s_add_u32 s63, s63, 131072
  v_add_u32 v122, s63, v116
  v_xor_b32 v123, 8192, v122
  v_lshlrev_b32 v124, 5, v1
  v_lshlrev_b32 v34, 3, v0
  v_add_u32 v34, 142944, v34
  s_mov_b32 s60, 0x3fb8aa3b
  s_waitcnt vmcnt(9)
  v_lshlrev_b32 v20, 16, v20
  v_mul_f32 v20, s60, v20
  v_exp_f32 v20, v20
  s_nop 0
  v_cvt_pk_bf16_f32 v20, v20, v20
  v_and_b32 v20, 0xffff0000, v20
  s_waitcnt vmcnt(8)
  v_lshlrev_b32 v16, 16, v16
  v_mul_f32 v16, s60, v16
  v_exp_f32 v16, v16
  s_nop 0
  v_cvt_pk_bf16_f32 v16, v16, v16
  v_and_b32 v16, 0xffff0000, v16
  s_waitcnt vmcnt(7)
  v_lshlrev_b32 v17, 16, v17
  s_waitcnt vmcnt(6)
  v_lshlrev_b32 v18, 16, v18
  s_waitcnt vmcnt(5)
  v_lshlrev_b32 v19, 16, v19
  v_mul_f32 v16, v16, v20
  v_mul_f32 v17, v17, v20
  v_mul_f32 v16, 0xbfb8aa3b, v16
  v_mul_f32 v17, 0.15915494, v17
  v_add_f32 v20, v20, v20
  v_mul_f32 v36, 0x41000000, v16
  v_mul_f32 v37, 0x41000000, v17
  v_exp_f32 v36, v36
  v_fract_f32 v37, v37
  v_cos_f32 v42, v37
  v_sin_f32 v43, v37
  s_nop 0
  v_pk_mul_f32 v[42:43], v[42:43], v[36:37] op_sel_hi:[1,0]
  v_mul_f32 v36, 0x43800000, v16
  v_mul_f32 v37, 0x43800000, v17
  v_exp_f32 v36, v36
  v_fract_f32 v37, v37
  v_cos_f32 v44, v37
  v_sin_f32 v45, v37
  s_nop 0
  v_pk_mul_f32 v[44:45], v[44:45], v[36:37] op_sel_hi:[1,0]
  v_exp_f32 v36, v16
  v_fract_f32 v37, v17
  v_cos_f32 v40, v37
  v_sin_f32 v41, v37
  s_nop 0
  v_pk_mul_f32 v[40:41], v[40:41], v[36:37] op_sel_hi:[1,0]
  s_waitcnt vmcnt(4)
  v_pk_mul_f32 v[18:19], v[18:19], v[20:21] op_sel_hi:[1,0]
  v_pk_mul_f32 v[56:57], v[42:43], v[42:43] op_sel:[0,0] op_sel_hi:[0,1]
  v_pk_mul_f32 v[68:69], v[18:19], v[44:45] op_sel:[0,0] op_sel_hi:[0,1]
  v_pk_mul_f32 v[46:47], v[40:41], v[40:41] op_sel:[0,0] op_sel_hi:[0,1]
  v_pk_mul_f32 v[84:85], v[18:19], v[40:41] op_sel:[0,0] op_sel_hi:[0,1]
  v_pk_fma_f32 v[56:57], v[42:43], v[42:43], v[56:57] op_sel:[1,1,0] op_sel_hi:[1,0,1] neg_lo:[1,0,0]
  v_pk_fma_f32 v[68:69], v[18:19], v[44:45], v[68:69] op_sel:[1,1,0] op_sel_hi:[1,0,1] neg_lo:[1,0,0]
  v_pk_fma_f32 v[46:47], v[40:41], v[40:41], v[46:47] op_sel:[1,1,0] op_sel_hi:[1,0,1] neg_lo:[1,0,0]
  v_pk_fma_f32 v[84:85], v[18:19], v[40:41], v[84:85] op_sel:[1,1,0] op_sel_hi:[1,0,1] neg_lo:[1,0,0]
  v_pk_mul_f32 v[58:59], v[56:57], v[42:43] op_sel:[0,0] op_sel_hi:[0,1]
  v_pk_mul_f32 v[50:51], v[56:57], v[56:57] op_sel:[0,0] op_sel_hi:[0,1]
  v_pk_mul_f32 v[70:71], v[68:69], v[44:45] op_sel:[0,0] op_sel_hi:[0,1]
  v_pk_mul_f32 v[48:49], v[46:47], v[46:47] op_sel:[0,0] op_sel_hi:[0,1]
  v_pk_mul_f32 v[86:87], v[18:19], v[46:47] op_sel:[0,0] op_sel_hi:[0,1]
  v_pk_fma_f32 v[58:59], v[56:57], v[42:43], v[58:59] op_sel:[1,1,0] op_sel_hi:[1,0,1] neg_lo:[1,0,0]
  v_pk_fma_f32 v[50:51], v[56:57], v[56:57], v[50:51] op_sel:[1,1,0] op_sel_hi:[1,0,1] neg_lo:[1,0,0]
  v_pk_fma_f32 v[70:71], v[68:69], v[44:45], v[70:71] op_sel:[1,1,0] op_sel_hi:[1,0,1] neg_lo:[1,0,0]
  v_pk_fma_f32 v[48:49], v[46:47], v[46:47], v[48:49] op_sel:[1,1,0] op_sel_hi:[1,0,1] neg_lo:[1,0,0]
  v_pk_fma_f32 v[86:87], v[18:19], v[46:47], v[86:87] op_sel:[1,1,0] op_sel_hi:[1,0,1] neg_lo:[1,0,0]
  s_mov_b32 m0, s65
  v_mov_b32 v100, 0x3f80
  v_cvt_pk_bf16_f32 v101, v42, v43
  v_cvt_pk_bf16_f32 v102, v56, v57
  v_cvt_pk_bf16_f32 v103, v58, v59
  v_cvt_pk_bf16_f32 v104, v50, v51
  ds_write_addtid_b32 v100 offset:0
  ds_write_addtid_b32 v101 offset:528
  ds_write_addtid_b32 v102 offset:1056
  ds_write_addtid_b32 v103 offset:1584
  ds_write_addtid_b32 v104 offset:2112
  v_pk_mul_f32 v[62:63], v[42:43], v[50:51] op_sel:[0,0] op_sel_hi:[0,1]
  v_pk_mul_f32 v[64:65], v[56:57], v[50:51] op_sel:[0,0] op_sel_hi:[0,1]
  v_pk_mul_f32 v[66:67], v[58:59], v[50:51] op_sel:[0,0] op_sel_hi:[0,1]
  v_pk_mul_f32 v[52:53], v[50:51], v[50:51] op_sel:[0,0] op_sel_hi:[0,1]
  v_pk_mul_f32 v[72:73], v[70:71], v[44:45] op_sel:[0,0] op_sel_hi:[0,1]
  v_pk_mul_f32 v[88:89], v[84:85], v[46:47] op_sel:[0,0] op_sel_hi:[0,1]
  v_pk_mul_f32 v[90:91], v[18:19], v[48:49] op_sel:[0,0] op_sel_hi:[0,1]
  v_pk_mul_f32 v[92:93], v[84:85], v[48:49] op_sel:[0,0] op_sel_hi:[0,1]
  v_pk_fma_f32 v[62:63], v[42:43], v[50:51], v[62:63] op_sel:[1,1,0] op_sel_hi:[1,0,1] neg_lo:[1,0,0]
  v_pk_fma_f32 v[64:65], v[56:57], v[50:51], v[64:65] op_sel:[1,1,0] op_sel_hi:[1,0,1] neg_lo:[1,0,0]
  v_pk_fma_f32 v[66:67], v[58:59], v[50:51], v[66:67] op_sel:[1,1,0] op_sel_hi:[1,0,1] neg_lo:[1,0,0]
  v_pk_fma_f32 v[52:53], v[50:51], v[50:51], v[52:53] op_sel:[1,1,0] op_sel_hi:[1,0,1] neg_lo:[1,0,0]
  v_pk_fma_f32 v[72:73], v[70:71], v[44:45], v[72:73] op_sel:[1,1,0] op_sel_hi:[1,0,1] neg_lo:[1,0,0]
  v_pk_fma_f32 v[88:89], v[84:85], v[46:47], v[88:89] op_sel:[1,1,0] op_sel_hi:[1,0,1] neg_lo:[1,0,0]
  v_pk_fma_f32 v[90:91], v[18:19], v[48:49], v[90:91] op_sel:[1,1,0] op_sel_hi:[1,0,1] neg_lo:[1,0,0]
  v_pk_fma_f32 v[92:93], v[84:85], v[48:49], v[92:93] op_sel:[1,1,0] op_sel_hi:[1,0,1] neg_lo:[1,0,0]
  s_mov_b32 m0, s98
  v_cvt_pk_bf16_f32 v105, v18, -v19
  v_cvt_pk_bf16_f32 v106, v84, -v85
  v_cvt_pk_bf16_f32 v107, v86, -v87
  v_cvt_pk_bf16_f32 v108, v88, -v89
  v_cvt_pk_bf16_f32 v109, v90, -v91
  v_cvt_pk_bf16_f32 v110, v92, -v93
  v_cvt_pk_bf16_f32 v111, v68, -v69
  v_cvt_pk_bf16_f32 v100, v70, -v71
  v_cvt_pk_bf16_f32 v101, v72, -v73
  ds_write_addtid_b32 v105 offset:51000
  ds_write_addtid_b32 v106 offset:51528
  ds_write_addtid_b32 v107 offset:52056
  ds_write_addtid_b32 v108 offset:52584
  ds_write_addtid_b32 v109 offset:53112
  ds_write_addtid_b32 v110 offset:53640
  ds_write_addtid_b32 v111 offset:55224
  ds_write_addtid_b32 v100 offset:57864
  ds_write_addtid_b32 v101 offset:59448
  s_mov_b32 m0, s65
  v_cvt_pk_bf16_f32 v102, v62, v63
  v_cvt_pk_bf16_f32 v103, v64, v65
  v_cvt_pk_bf16_f32 v104, v66, v67
  v_cvt_pk_bf16_f32 v105, v52, v53
  ds_write_addtid_b32 v102 offset:2640
  ds_write_addtid_b32 v103 offset:3168
  ds_write_addtid_b32 v104 offset:3696
  ds_write_addtid_b32 v105 offset:4224
  v_pk_mul_f32 v[54:55], v[62:63], v[50:51] op_sel:[0,0] op_sel_hi:[0,1]
  v_pk_mul_f32 v[56:57], v[64:65], v[50:51] op_sel:[0,0] op_sel_hi:[0,1]
  v_pk_mul_f32 v[58:59], v[66:67], v[50:51] op_sel:[0,0] op_sel_hi:[0,1]
  v_pk_mul_f32 v[60:61], v[52:53], v[50:51] op_sel:[0,0] op_sel_hi:[0,1]
  v_pk_mul_f32 v[74:75], v[72:73], v[44:45] op_sel:[0,0] op_sel_hi:[0,1]
  v_pk_mul_f32 v[90:91], v[86:87], v[48:49] op_sel:[0,0] op_sel_hi:[0,1]
  v_pk_mul_f32 v[92:93], v[88:89], v[48:49] op_sel:[0,0] op_sel_hi:[0,1]
  v_pk_fma_f32 v[54:55], v[62:63], v[50:51], v[54:55] op_sel:[1,1,0] op_sel_hi:[1,0,1] neg_lo:[1,0,0]
  v_pk_fma_f32 v[56:57], v[64:65], v[50:51], v[56:57] op_sel:[1,1,0] op_sel_hi:[1,0,1] neg_lo:[1,0,0]
  v_pk_fma_f32 v[58:59], v[66:67], v[50:51], v[58:59] op_sel:[1,1,0] op_sel_hi:[1,0,1] neg_lo:[1,0,0]
  v_pk_fma_f32 v[60:61], v[52:53], v[50:51], v[60:61] op_sel:[1,1,0] op_sel_hi:[1,0,1] neg_lo:[1,0,0]
  v_pk_fma_f32 v[74:75], v[72:73], v[44:45], v[74:75] op_sel:[1,1,0] op_sel_hi:[1,0,1] neg_lo:[1,0,0]
  v_pk_fma_f32 v[90:91], v[86:87], v[48:49], v[90:91] op_sel:[1,1,0] op_sel_hi:[1,0,1] neg_lo:[1,0,0]
  v_pk_fma_f32 v[92:93], v[88:89], v[48:49], v[92:93] op_sel:[1,1,0] op_sel_hi:[1,0,1] neg_lo:[1,0,0]
  s_mov_b32 m0, s65
  v_cvt_pk_bf16_f32 v106, v54, v55
  v_cvt_pk_bf16_f32 v107, v56, v57
  v_cvt_pk_bf16_f32 v108, v58, v59
  v_cvt_pk_bf16_f32 v109, v60, v61
  ds_write_addtid_b32 v106 offset:4752
  ds_write_addtid_b32 v107 offset:5280
  ds_write_addtid_b32 v108 offset:5808
  ds_write_addtid_b32 v109 offset:6336
  s_mov_b32 m0, s98
  v_cvt_pk_bf16_f32 v110, v74, -v75
  v_cvt_pk_bf16_f32 v111, v90, -v91
  v_cvt_pk_bf16_f32 v100, v92, -v93
  ds_write_addtid_b32 v110 offset:61032
  ds_write_addtid_b32 v111 offset:54168
  ds_write_addtid_b32 v100 offset:54696
  v_pk_mul_f32 v[62:63], v[54:55], v[50:51] op_sel:[0,0] op_sel_hi:[0,1]
  v_pk_mul_f32 v[64:65], v[56:57], v[50:51] op_sel:[0,0] op_sel_hi:[0,1]
  v_pk_mul_f32 v[66:67], v[58:59], v[50:51] op_sel:[0,0] op_sel_hi:[0,1]
  v_pk_mul_f32 v[52:53], v[60:61], v[50:51] op_sel:[0,0] op_sel_hi:[0,1]
  v_pk_mul_f32 v[76:77], v[74:75], v[44:45] op_sel:[0,0] op_sel_hi:[0,1]
  v_pk_mul_f32 v[90:91], v[68:69], v[46:47] op_sel:[0,0] op_sel_hi:[0,1]
  v_pk_mul_f32 v[82:83], v[68:69], v[48:49] op_sel:[0,0] op_sel_hi:[0,1]
  v_pk_fma_f32 v[62:63], v[54:55], v[50:51], v[62:63] op_sel:[1,1,0] op_sel_hi:[1,0,1] neg_lo:[1,0,0]
  v_pk_fma_f32 v[64:65], v[56:57], v[50:51], v[64:65] op_sel:[1,1,0] op_sel_hi:[1,0,1] neg_lo:[1,0,0]
  v_pk_fma_f32 v[66:67], v[58:59], v[50:51], v[66:67] op_sel:[1,1,0] op_sel_hi:[1,0,1] neg_lo:[1,0,0]
  v_pk_fma_f32 v[52:53], v[60:61], v[50:51], v[52:53] op_sel:[1,1,0] op_sel_hi:[1,0,1] neg_lo:[1,0,0]
  v_pk_fma_f32 v[76:77], v[74:75], v[44:45], v[76:77] op_sel:[1,1,0] op_sel_hi:[1,0,1] neg_lo:[1,0,0]
  v_pk_fma_f32 v[90:91], v[68:69], v[46:47], v[90:91] op_sel:[1,1,0] op_sel_hi:[1,0,1] neg_lo:[1,0,0]
  v_pk_fma_f32 v[82:83], v[68:69], v[48:49], v[82:83] op_sel:[1,1,0] op_sel_hi:[1,0,1] neg_lo:[1,0,0]
  s_mov_b32 m0, s65
  v_cvt_pk_bf16_f32 v101, v62, v63
  v_cvt_pk_bf16_f32 v102, v64, v65
  v_cvt_pk_bf16_f32 v103, v66, v67
  v_cvt_pk_bf16_f32 v104, v52, v53
  ds_write_addtid_b32 v101 offset:6864
  ds_write_addtid_b32 v102 offset:7392
  ds_write_addtid_b32 v103 offset:7920
  ds_write_addtid_b32 v104 offset:8448
  s_mov_b32 m0, s98
  v_cvt_pk_bf16_f32 v105, v76, -v77
  v_cvt_pk_bf16_f32 v106, v90, -v91
  v_cvt_pk_bf16_f32 v107, v82, -v83
  ds_write_addtid_b32 v105 offset:62088
  ds_write_addtid_b32 v106 offset:55752
  ds_write_addtid_b32 v107 offset:56280
  v_pk_mul_f32 v[54:55], v[62:63], v[50:51] op_sel:[0,0] op_sel_hi:[0,1]
  v_pk_mul_f32 v[56:57], v[64:65], v[50:51] op_sel:[0,0] op_sel_hi:[0,1]
  v_pk_mul_f32 v[58:59], v[66:67], v[50:51] op_sel:[0,0] op_sel_hi:[0,1]
  v_pk_mul_f32 v[60:61], v[52:53], v[50:51] op_sel:[0,0] op_sel_hi:[0,1]
  v_pk_mul_f32 v[78:79], v[76:77], v[44:45] op_sel:[0,0] op_sel_hi:[0,1]
  v_pk_mul_f32 v[90:91], v[82:83], v[46:47] op_sel:[0,0] op_sel_hi:[0,1]
  v_pk_mul_f32 v[92:93], v[68:69], v[42:43] op_sel:[0,0] op_sel_hi:[0,1]
  v_pk_mul_f32 v[94:95], v[70:71], v[48:49] op_sel:[0,0] op_sel_hi:[0,1]
  v_pk_fma_f32 v[54:55], v[62:63], v[50:51], v[54:55] op_sel:[1,1,0] op_sel_hi:[1,0,1] neg_lo:[1,0,0]
  v_pk_fma_f32 v[56:57], v[64:65], v[50:51], v[56:57] op_sel:[1,1,0] op_sel_hi:[1,0,1] neg_lo:[1,0,0]
  v_pk_fma_f32 v[58:59], v[66:67], v[50:51], v[58:59] op_sel:[1,1,0] op_sel_hi:[1,0,1] neg_lo:[1,0,0]
  v_pk_fma_f32 v[60:61], v[52:53], v[50:51], v[60:61] op_sel:[1,1,0] op_sel_hi:[1,0,1] neg_lo:[1,0,0]
  v_pk_fma_f32 v[78:79], v[76:77], v[44:45], v[78:79] op_sel:[1,1,0] op_sel_hi:[1,0,1] neg_lo:[1,0,0]
  v_pk_fma_f32 v[90:91], v[82:83], v[46:47], v[90:91] op_sel:[1,1,0] op_sel_hi:[1,0,1] neg_lo:[1,0,0]
  v_pk_fma_f32 v[92:93], v[68:69], v[42:43], v[92:93] op_sel:[1,1,0] op_sel_hi:[1,0,1] neg_lo:[1,0,0]
  v_pk_fma_f32 v[94:95], v[70:71], v[48:49], v[94:95] op_sel:[1,1,0] op_sel_hi:[1,0,1] neg_lo:[1,0,0]
  s_mov_b32 m0, s65
  v_cvt_pk_bf16_f32 v108, v54, v55
  v_cvt_pk_bf16_f32 v109, v56, v57
  v_cvt_pk_bf16_f32 v110, v58, v59
  v_cvt_pk_bf16_f32 v111, v60, v61
  ds_write_addtid_b32 v108 offset:8976
  ds_write_addtid_b32 v109 offset:9504
  ds_write_addtid_b32 v110 offset:10032
  ds_write_addtid_b32 v111 offset:10560
  s_mov_b32 m0, s98
  v_cvt_pk_bf16_f32 v100, v78, -v79
  v_cvt_pk_bf16_f32 v101, v90, -v91
  v_cvt_pk_bf16_f32 v102, v92, -v93
  v_cvt_pk_bf16_f32 v103, v94, -v95
  ds_write_addtid_b32 v100 offset:63144
  ds_write_addtid_b32 v101 offset:56808
  ds_write_addtid_b32 v102 offset:57336
  ds_write_addtid_b32 v103 offset:58392
  v_pk_mul_f32 v[62:63], v[54:55], v[50:51] op_sel:[0,0] op_sel_hi:[0,1]
  v_pk_mul_f32 v[64:65], v[56:57], v[50:51] op_sel:[0,0] op_sel_hi:[0,1]
  v_pk_mul_f32 v[66:67], v[58:59], v[50:51] op_sel:[0,0] op_sel_hi:[0,1]
  v_pk_mul_f32 v[52:53], v[60:61], v[50:51] op_sel:[0,0] op_sel_hi:[0,1]
  v_pk_mul_f32 v[80:81], v[78:79], v[44:45] op_sel:[0,0] op_sel_hi:[0,1]
  v_pk_mul_f32 v[90:91], v[70:71], v[42:43] op_sel:[0,0] op_sel_hi:[0,1]
  v_pk_mul_f32 v[92:93], v[72:73], v[48:49] op_sel:[0,0] op_sel_hi:[0,1]
  v_pk_mul_f32 v[94:95], v[72:73], v[42:43] op_sel:[0,0] op_sel_hi:[0,1]
  v_pk_fma_f32 v[62:63], v[54:55], v[50:51], v[62:63] op_sel:[1,1,0] op_sel_hi:[1,0,1] neg_lo:[1,0,0]
  v_pk_fma_f32 v[64:65], v[56:57], v[50:51], v[64:65] op_sel:[1,1,0] op_sel_hi:[1,0,1] neg_lo:[1,0,0]
  v_pk_fma_f32 v[66:67], v[58:59], v[50:51], v[66:67] op_sel:[1,1,0] op_sel_hi:[1,0,1] neg_lo:[1,0,0]
  v_pk_fma_f32 v[52:53], v[60:61], v[50:51], v[52:53] op_sel:[1,1,0] op_sel_hi:[1,0,1] neg_lo:[1,0,0]
  v_pk_fma_f32 v[80:81], v[78:79], v[44:45], v[80:81] op_sel:[1,1,0] op_sel_hi:[1,0,1] neg_lo:[1,0,0]
  v_pk_fma_f32 v[90:91], v[70:71], v[42:43], v[90:91] op_sel:[1,1,0] op_sel_hi:[1,0,1] neg_lo:[1,0,0]
  v_pk_fma_f32 v[92:93], v[72:73], v[48:49], v[92:93] op_sel:[1,1,0] op_sel_hi:[1,0,1] neg_lo:[1,0,0]
  v_pk_fma_f32 v[94:95], v[72:73], v[42:43], v[94:95] op_sel:[1,1,0] op_sel_hi:[1,0,1] neg_lo:[1,0,0]
  s_mov_b32 m0, s65
  v_cvt_pk_bf16_f32 v104, v62, v63
  v_cvt_pk_bf16_f32 v105, v64, v65
  v_cvt_pk_bf16_f32 v106, v66, v67
  v_cvt_pk_bf16_f32 v107, v52, v53
  ds_write_addtid_b32 v104 offset:11088
  ds_write_addtid_b32 v105 offset:11616
  ds_write_addtid_b32 v106 offset:12144
  ds_write_addtid_b32 v107 offset:12672
  s_mov_b32 m0, s98
  v_cvt_pk_bf16_f32 v108, v80, -v81
  v_cvt_pk_bf16_f32 v109, v90, -v91
  v_cvt_pk_bf16_f32 v110, v92, -v93
  v_cvt_pk_bf16_f32 v111, v94, -v95
  ds_write_addtid_b32 v108 offset:64200
  ds_write_addtid_b32 v109 offset:58920
  ds_write_addtid_b32 v110 offset:59976
  ds_write_addtid_b32 v111 offset:60504
  v_pk_mul_f32 v[54:55], v[62:63], v[50:51] op_sel:[0,0] op_sel_hi:[0,1]
  v_pk_mul_f32 v[56:57], v[64:65], v[50:51] op_sel:[0,0] op_sel_hi:[0,1]
  v_pk_mul_f32 v[58:59], v[66:67], v[50:51] op_sel:[0,0] op_sel_hi:[0,1]
  v_pk_mul_f32 v[60:61], v[52:53], v[50:51] op_sel:[0,0] op_sel_hi:[0,1]
  v_pk_mul_f32 v[90:91], v[74:75], v[42:43] op_sel:[0,0] op_sel_hi:[0,1]
  v_pk_mul_f32 v[92:93], v[76:77], v[42:43] op_sel:[0,0] op_sel_hi:[0,1]
  v_pk_mul_f32 v[94:95], v[78:79], v[42:43] op_sel:[0,0] op_sel_hi:[0,1]
  v_pk_fma_f32 v[54:55], v[62:63], v[50:51], v[54:55] op_sel:[1,1,0] op_sel_hi:[1,0,1] neg_lo:[1,0,0]
  v_pk_fma_f32 v[56:57], v[64:65], v[50:51], v[56:57] op_sel:[1,1,0] op_sel_hi:[1,0,1] neg_lo:[1,0,0]
  v_pk_fma_f32 v[58:59], v[66:67], v[50:51], v[58:59] op_sel:[1,1,0] op_sel_hi:[1,0,1] neg_lo:[1,0,0]
  v_pk_fma_f32 v[60:61], v[52:53], v[50:51], v[60:61] op_sel:[1,1,0] op_sel_hi:[1,0,1] neg_lo:[1,0,0]
  v_pk_fma_f32 v[90:91], v[74:75], v[42:43], v[90:91] op_sel:[1,1,0] op_sel_hi:[1,0,1] neg_lo:[1,0,0]
  v_pk_fma_f32 v[92:93], v[76:77], v[42:43], v[92:93] op_sel:[1,1,0] op_sel_hi:[1,0,1] neg_lo:[1,0,0]
  v_pk_fma_f32 v[94:95], v[78:79], v[42:43], v[94:95] op_sel:[1,1,0] op_sel_hi:[1,0,1] neg_lo:[1,0,0]
  s_mov_b32 m0, s65
  v_cvt_pk_bf16_f32 v100, v54, v55
  v_cvt_pk_bf16_f32 v101, v56, v57
  v_cvt_pk_bf16_f32 v102, v58, v59
  v_cvt_pk_bf16_f32 v103, v60, v61
  ds_write_addtid_b32 v100 offset:13200
  ds_write_addtid_b32 v101 offset:13728
  ds_write_addtid_b32 v102 offset:14256
  ds_write_addtid_b32 v103 offset:14784
  s_mov_b32 m0, s98
  v_cvt_pk_bf16_f32 v104, v90, -v91
  v_cvt_pk_bf16_f32 v105, v92, -v93
  v_cvt_pk_bf16_f32 v106, v94, -v95
  ds_write_addtid_b32 v104 offset:61560
  ds_write_addtid_b32 v105 offset:62616
  ds_write_addtid_b32 v106 offset:63672
  v_pk_mul_f32 v[62:63], v[54:55], v[50:51] op_sel:[0,0] op_sel_hi:[0,1]
  v_pk_mul_f32 v[64:65], v[56:57], v[50:51] op_sel:[0,0] op_sel_hi:[0,1]
  v_pk_mul_f32 v[66:67], v[58:59], v[50:51] op_sel:[0,0] op_sel_hi:[0,1]
  v_pk_mul_f32 v[90:91], v[80:81], v[42:43] op_sel:[0,0] op_sel_hi:[0,1]
  v_pk_fma_f32 v[62:63], v[54:55], v[50:51], v[62:63] op_sel:[1,1,0] op_sel_hi:[1,0,1] neg_lo:[1,0,0]
  v_pk_fma_f32 v[64:65], v[56:57], v[50:51], v[64:65] op_sel:[1,1,0] op_sel_hi:[1,0,1] neg_lo:[1,0,0]
  v_pk_fma_f32 v[66:67], v[58:59], v[50:51], v[66:67] op_sel:[1,1,0] op_sel_hi:[1,0,1] neg_lo:[1,0,0]
  v_pk_fma_f32 v[90:91], v[80:81], v[42:43], v[90:91] op_sel:[1,1,0] op_sel_hi:[1,0,1] neg_lo:[1,0,0]
  s_mov_b32 m0, s65
  v_cvt_pk_bf16_f32 v107, v62, v63
  v_cvt_pk_bf16_f32 v108, v64, v65
  v_cvt_pk_bf16_f32 v109, v66, v67
  ds_write_addtid_b32 v107 offset:15312
  ds_write_addtid_b32 v108 offset:15840
  ds_write_addtid_b32 v109 offset:16368
  s_mov_b32 m0, s98
  v_cvt_pk_bf16_f32 v110, v90, -v91
  ds_write_addtid_b32 v110 offset:64728
  v_or_b32 v4, s3, v1
  v_cmp_eq_u32 vcc, 0, v4
  v_lshlrev_b32 v21, 16, v21
  s_nop 0
  v_cndmask_b32 v21, 0, v21, vcc
  s_waitcnt lgkmcnt(0)
  s_barrier
  ds_read_b128 v[48:51], v22 offset:0
  ds_read_b128 v[64:67], v23 offset:0
  ds_read_b128 v[68:71], v24 offset:0
  ds_read_b128 v[52:55], v22 offset:64
  ds_read_b128 v[72:75], v23 offset:64
  ds_read_b128 v[76:79], v24 offset:64
  ds_read_b128 v[56:59], v22 offset:128
  ds_read_b128 v[80:83], v23 offset:128
  ds_read_b128 v[84:87], v24 offset:128
  ds_read_b128 v[60:63], v22 offset:192
  ds_read_b128 v[88:91], v23 offset:192
  ds_read_b128 v[92:95], v24 offset:192
  s_waitcnt lgkmcnt(10)
  v_mfma_f32_16x16x32_bf16 v[40:43], v[64:67], v[48:51], 0
  s_waitcnt lgkmcnt(9)
  v_mfma_f32_16x16x32_bf16 v[44:47], v[68:71], v[48:51], 0
  ds_read_b128 v[48:51], v22 offset:256
  ds_read_b128 v[64:67], v23 offset:256
  ds_read_b128 v[68:71], v24 offset:256
  s_waitcnt lgkmcnt(10)
  v_mfma_f32_16x16x32_bf16 v[40:43], v[72:75], v[52:55], v[40:43]
  s_waitcnt lgkmcnt(9)
  v_mfma_f32_16x16x32_bf16 v[44:47], v[76:79], v[52:55], v[44:47]
  ds_read_b128 v[52:55], v22 offset:320
  ds_read_b128 v[72:75], v23 offset:320
  ds_read_b128 v[76:79], v24 offset:320
  s_waitcnt lgkmcnt(10)
  v_mfma_f32_16x16x32_bf16 v[40:43], v[80:83], v[56:59], v[40:43]
  s_waitcnt lgkmcnt(9)
  v_mfma_f32_16x16x32_bf16 v[44:47], v[84:87], v[56:59], v[44:47]
  ds_read_b128 v[56:59], v22 offset:384
  ds_read_b128 v[80:83], v23 offset:384
  ds_read_b128 v[84:87], v24 offset:384
  s_waitcnt lgkmcnt(10)
  v_mfma_f32_16x16x32_bf16 v[40:43], v[88:91], v[60:63], v[40:43]
  s_waitcnt lgkmcnt(9)
  v_mfma_f32_16x16x32_bf16 v[44:47], v[92:95], v[60:63], v[44:47]
  ds_read_b128 v[60:63], v22 offset:448
  ds_read_b128 v[88:91], v23 offset:448
  ds_read_b128 v[92:95], v24 offset:448
  s_waitcnt lgkmcnt(10)
  v_mfma_f32_16x16x32_bf16 v[40:43], v[64:67], v[48:51], v[40:43]
  s_waitcnt lgkmcnt(9)
  v_mfma_f32_16x16x32_bf16 v[44:47], v[68:71], v[48:51], v[44:47]
  s_waitcnt lgkmcnt(7)
  v_mfma_f32_16x16x32_bf16 v[40:43], v[72:75], v[52:55], v[40:43]
  s_waitcnt lgkmcnt(6)
  v_mfma_f32_16x16x32_bf16 v[44:47], v[76:79], v[52:55], v[44:47]
  s_waitcnt lgkmcnt(4)
  v_mfma_f32_16x16x32_bf16 v[40:43], v[80:83], v[56:59], v[40:43]
  s_waitcnt lgkmcnt(3)
  v_mfma_f32_16x16x32_bf16 v[44:47], v[84:87], v[56:59], v[44:47]
  s_waitcnt lgkmcnt(1)
  v_mfma_f32_16x16x32_bf16 v[40:43], v[88:91], v[60:63], v[40:43]
  s_waitcnt lgkmcnt(0)
  v_mfma_f32_16x16x32_bf16 v[44:47], v[92:95], v[60:63], v[44:47]
  v_and_b32 v4, 1, v1
  v_cmp_eq_u32 vcc, 0, v4
  s_nop 3
  v_add_f32 v40, v40, v21
  s_mov_b32 exec_hi, 0
  v_cvt_pk_bf16_f32 v48, v47, v46
  v_cvt_pk_bf16_f32 v49, v45, v44
  v_cvt_pk_bf16_f32 v50, v43, v42
  v_cvt_pk_bf16_f32 v51, v41, v40
  s_mov_b32 exec_lo, 0
  s_mov_b32 exec_hi, -1
  v_cvt_pk_bf16_f32 v48, v42, v42
  v_cvt_pk_bf16_f32 v49, v41, v41
  v_cvt_pk_bf16_f32 v50, v41, v40
  v_cvt_pk_bf16_f32 v51, v40, v40
  v_cndmask_b32 v4, v44, v43, vcc
  v_cvt_pk_bf16_f32 v52, v44, v44
  v_cvt_pk_bf16_f32 v53, v44, v4
  v_cvt_pk_bf16_f32 v54, v43, v43
  v_mov_b32 v55, v54
  ds_write_b128 v27, v[52:55] offset:512
  v_cndmask_b32 v4, v46, v45, vcc
  v_cvt_pk_bf16_f32 v56, v46, v46
  v_cvt_pk_bf16_f32 v57, v46, v4
  v_cvt_pk_bf16_f32 v58, v45, v45
  v_mov_b32 v59, v58
  ds_write_b128 v27, v[56:59]
  s_mov_b64 exec, -1
  ds_write_b128 v25, v[48:51]
  s_mov_b32 s62, 0x05040100
  s_waitcnt vmcnt(2)
  v_perm_b32 v36, v10, v8, s62
  s_waitcnt vmcnt(0)
  v_perm_b32 v37, v14, v12, s62
  ds_write_b64 v34, v[36:37] offset:0
  s_mov_b32 s62, 0x07060302
  v_perm_b32 v38, v10, v8, s62
  v_perm_b32 v39, v14, v12, s62
  ds_write_b64 v34, v[38:39] offset:4128
  s_mov_b32 s62, 0x05040100
  v_perm_b32 v36, v11, v9, s62
  v_perm_b32 v37, v15, v13, s62
  ds_write_b64 v34, v[36:37] offset:8256
  s_mov_b32 s62, 0x07060302
  v_perm_b32 v38, v11, v9, s62
  v_perm_b32 v39, v15, v13, s62
  ds_write_b64 v34, v[38:39] offset:12384
  v_mov_b32 v12, -1
  v_mov_b32 v13, -1
  v_mov_b32 v14, -1
  v_mov_b32 v15, -1
  v_lshrrev_b32 v4, 3, v1
  v_and_b32 v4, 4, v4
  s_and_b32 s62, s4, 1
  s_lshl_b32 s62, s62, 1
  v_xor_b32 v4, s62, v4
  v_and_b32 v5, 7, v1
  v_xor_b32 v4, v4, v5
  v_lshlrev_b32 v4, 4, v4
  v_lshrrev_b32 v5, 3, v1
  v_lshl_add_u32 v8, v5, 10, v4
  s_mov_b32 s52, s28
  s_and_b32 s53, s29, 0xffff
  s_mov_b32 s54, 0x80000
  s_mov_b32 s55, 0x20000
  s_waitcnt lgkmcnt(0)
  s_barrier
  buffer_store_dwordx4 v[12:15], v116, s[48:51], s17 offen sc1
  buffer_store_dwordx4 v[12:15], v116, s[48:51], s17 offen offset:1024 sc1
  s_add_u32 m0, s23, 0
  s_add_u32 s62, s22, 0
  buffer_load_dwordx4 v8, s[52:55], s62 offen lds
  s_add_u32 m0, s23, 1024
  s_add_u32 s62, s22, 65536
  buffer_load_dwordx4 v8, s[52:55], s62 offen lds
  s_add_u32 m0, s23, 2048
  s_add_u32 s62, s22, 131072
  buffer_load_dwordx4 v8, s[52:55], s62 offen lds
  s_add_u32 m0, s23, 3072
  s_add_u32 s62, s22, 196608
  buffer_load_dwordx4 v8, s[52:55], s62 offen lds
  s_add_u32 m0, s23, 32768
  s_add_u32 s62, s22, 262144
  buffer_load_dwordx4 v8, s[52:55], s62 offen lds
  s_add_u32 m0, s23, 33792
  s_add_u32 s62, s22, 327680
  buffer_load_dwordx4 v8, s[52:55], s62 offen lds
  s_add_u32 m0, s23, 34816
  s_add_u32 s62, s22, 393216
  buffer_load_dwordx4 v8, s[52:55], s62 offen lds
  s_add_u32 m0, s23, 35840
  s_add_u32 s62, s22, 458752
  buffer_load_dwordx4 v8, s[52:55], s62 offen lds
  ds_read2_b32 v[72:73], v28 offset0:0 offset1:1
  ds_read2_b32 v[74:75], v28 offset0:2 offset1:3
  ds_read_b32 v76, v28 offset:16
  ds_read_b128 a[0:3], v26 offset:3584
  ds_read_b128 a[4:7], v26 offset:3072
  ds_read_b128 a[8:11], v26 offset:2560
  ds_read_b128 a[12:15], v26 offset:2048
  ds_read_b128 a[16:19], v26 offset:1536
  ds_read_b128 a[20:23], v26 offset:1024
  ds_read_b128 a[24:27], v26 offset:512
  ds_read_b128 a[28:31], v26 offset:0
  ds_read2_b32 v[78:79], v28 offset0:16 offset1:17
  ds_read2_b32 v[80:81], v28 offset0:18 offset1:19
  ds_read_b32 v82, v28 offset:80
  s_waitcnt lgkmcnt(13)
  v_alignbit_b32 v96, v73, v72, v32
  s_waitcnt lgkmcnt(12)
  v_alignbit_b32 v97, v74, v73, v32
  v_alignbit_b32 v98, v75, v74, v32
  s_waitcnt lgkmcnt(11)
  v_alignbit_b32 v99, v76, v75, v32
  ds_read2_b32 v[84:85], v28 offset0:32 offset1:33
  ds_read2_b32 v[86:87], v28 offset0:34 offset1:35
  ds_read_b32 v88, v28 offset:144
  s_waitcnt lgkmcnt(13)
  v_mfma_f32_16x16x32_bf16 v[40:43], v[96:99], a[0:3], 0
  ds_read_b128 a[32:35], v26 offset:3648
  ds_read_b128 a[36:39], v26 offset:3136
  ds_read_b128 a[40:43], v26 offset:2624
  ds_read_b128 a[44:47], v26 offset:2112
  ds_read_b128 a[48:51], v26 offset:1600
  ds_read_b128 a[52:55], v26 offset:1088
  ds_read_b128 a[56:59], v26 offset:576
  ds_read_b128 a[60:63], v26 offset:64
  ds_read2_b32 v[90:91], v28 offset0:48 offset1:49
  ds_read2_b32 v[92:93], v28 offset0:50 offset1:51
  ds_read_b32 v94, v28 offset:208
  s_waitcnt lgkmcnt(15)
  v_mfma_f32_16x16x32_bf16 v[44:47], v[96:99], a[4:7], 0
  v_alignbit_b32 v100, v79, v78, v32
  v_alignbit_b32 v101, v80, v79, v32
  v_alignbit_b32 v102, v81, v80, v32
  s_waitcnt lgkmcnt(14)
  v_alignbit_b32 v103, v82, v81, v32
  v_mfma_f32_16x16x32_bf16 v[48:51], v[96:99], a[8:11], 0
  v_mfma_f32_16x16x32_bf16 v[52:55], v[96:99], a[12:15], 0
  v_mfma_f32_16x16x32_bf16 v[56:59], v[96:99], a[16:19], 0
  v_mfma_f32_16x16x32_bf16 v[60:63], v[96:99], a[20:23], 0
  v_mfma_f32_16x16x32_bf16 v[64:67], v[96:99], a[24:27], 0
  v_mfma_f32_16x16x32_bf16 v[68:71], v[96:99], a[28:31], 0
  s_waitcnt lgkmcnt(10)
  v_mfma_f32_16x16x32_bf16 v[40:43], v[100:103], a[32:35], v[40:43]
  ds_read_b128 a[64:67], v26 offset:3712
  ds_read_b128 a[68:71], v26 offset:3200
  ds_read_b128 a[72:75], v26 offset:2688
  ds_read_b128 a[76:79], v26 offset:2176
  ds_read_b128 a[80:83], v26 offset:1664
  ds_read_b128 a[84:87], v26 offset:1152
  ds_read_b128 a[88:91], v26 offset:640
  ds_read_b128 a[92:95], v26 offset:128
  ds_read2_b32 v[72:73], v28 offset0:128 offset1:129
  ds_read2_b32 v[74:75], v28 offset0:130 offset1:131
  ds_read_b32 v76, v28 offset:528
  s_waitcnt lgkmcnt(15)
  v_mfma_f32_16x16x32_bf16 v[44:47], v[100:103], a[36:39], v[44:47]
  v_alignbit_b32 v104, v85, v84, v32
  v_alignbit_b32 v105, v86, v85, v32
  v_alignbit_b32 v106, v87, v86, v32
  v_alignbit_b32 v107, v88, v87, v32
  v_mfma_f32_16x16x32_bf16 v[48:51], v[100:103], a[40:43], v[48:51]
  v_mfma_f32_16x16x32_bf16 v[52:55], v[100:103], a[44:47], v[52:55]
  v_mfma_f32_16x16x32_bf16 v[56:59], v[100:103], a[48:51], v[56:59]
  v_mfma_f32_16x16x32_bf16 v[60:63], v[100:103], a[52:55], v[60:63]
  v_mfma_f32_16x16x32_bf16 v[64:67], v[100:103], a[56:59], v[64:67]
  s_waitcnt lgkmcnt(14)
  v_mfma_f32_16x16x32_bf16 v[68:71], v[100:103], a[60:63], v[68:71]
  s_waitcnt lgkmcnt(10)
  v_mfma_f32_16x16x32_bf16 v[40:43], v[104:107], a[64:67], v[40:43]
  ds_read_b128 a[96:99], v26 offset:3776
  ds_read_b128 a[100:103], v26 offset:3264
  ds_read_b128 a[104:107], v26 offset:2752
  ds_read_b128 a[108:111], v26 offset:2240
  ds_read_b128 a[112:115], v26 offset:1728
  ds_read_b128 a[116:119], v26 offset:1216
  ds_read_b128 a[120:123], v26 offset:704
  ds_read_b128 a[124:127], v26 offset:192
  ds_read2_b32 v[78:79], v28 offset0:144 offset1:145
  ds_read2_b32 v[80:81], v28 offset0:146 offset1:147
  ds_read_b32 v82, v28 offset:592
  s_waitcnt lgkmcnt(15)
  v_mfma_f32_16x16x32_bf16 v[44:47], v[104:107], a[68:71], v[44:47]
  v_alignbit_b32 v108, v91, v90, v32
  v_alignbit_b32 v109, v92, v91, v32
  v_alignbit_b32 v110, v93, v92, v32
  v_alignbit_b32 v111, v94, v93, v32
  v_mfma_f32_16x16x32_bf16 v[48:51], v[104:107], a[72:75], v[48:51]
  v_mfma_f32_16x16x32_bf16 v[52:55], v[104:107], a[76:79], v[52:55]
  v_mfma_f32_16x16x32_bf16 v[56:59], v[104:107], a[80:83], v[56:59]
  v_mfma_f32_16x16x32_bf16 v[60:63], v[104:107], a[84:87], v[60:63]
  v_mfma_f32_16x16x32_bf16 v[64:67], v[104:107], a[88:91], v[64:67]
  s_waitcnt lgkmcnt(14)
  v_mfma_f32_16x16x32_bf16 v[68:71], v[104:107], a[92:95], v[68:71]
  s_waitcnt lgkmcnt(10)
  v_mfma_f32_16x16x32_bf16 v[40:43], v[108:111], a[96:99], v[40:43]
  ds_read2_b32 v[84:85], v28 offset0:160 offset1:161
  ds_read2_b32 v[86:87], v28 offset0:162 offset1:163
  ds_read_b32 v88, v28 offset:656
  s_waitcnt lgkmcnt(12)
  v_mfma_f32_16x16x32_bf16 v[44:47], v[108:111], a[100:103], v[44:47]
  v_alignbit_b32 v96, v73, v72, v32
  v_alignbit_b32 v97, v74, v73, v32
  v_alignbit_b32 v98, v75, v74, v32
  v_alignbit_b32 v99, v76, v75, v32
  s_waitcnt lgkmcnt(11)
  v_mfma_f32_16x16x32_bf16 v[48:51], v[108:111], a[104:107], v[48:51]
  s_waitcnt lgkmcnt(10)
  v_mfma_f32_16x16x32_bf16 v[52:55], v[108:111], a[108:111], v[52:55]
  s_waitcnt lgkmcnt(9)
  v_mfma_f32_16x16x32_bf16 v[56:59], v[108:111], a[112:115], v[56:59]
  s_waitcnt lgkmcnt(8)
  v_mfma_f32_16x16x32_bf16 v[60:63], v[108:111], a[116:119], v[60:63]
  s_waitcnt lgkmcnt(7)
  v_mfma_f32_16x16x32_bf16 v[64:67], v[108:111], a[120:123], v[64:67]
  s_waitcnt lgkmcnt(6)
  v_mfma_f32_16x16x32_bf16 v[68:71], v[108:111], a[124:127], v[68:71]
  v_mfma_f32_16x16x32_bf16 v[44:47], v[96:99], a[0:3], v[44:47]
  ds_read2_b32 v[90:91], v28 offset0:176 offset1:177
  ds_read2_b32 v[92:93], v28 offset0:178 offset1:179
  ds_read_b32 v94, v28 offset:720
  v_mfma_f32_16x16x32_bf16 v[48:51], v[96:99], a[4:7], v[48:51]
  s_waitcnt lgkmcnt(8)
  v_alignbit_b32 v100, v79, v78, v32
  s_waitcnt lgkmcnt(7)
  v_alignbit_b32 v101, v80, v79, v32
  v_alignbit_b32 v102, v81, v80, v32
  s_waitcnt lgkmcnt(6)
  v_alignbit_b32 v103, v82, v81, v32
  v_mfma_f32_16x16x32_bf16 v[52:55], v[96:99], a[8:11], v[52:55]
  v_mfma_f32_16x16x32_bf16 v[56:59], v[96:99], a[12:15], v[56:59]
  v_mfma_f32_16x16x32_bf16 v[60:63], v[96:99], a[16:19], v[60:63]
  v_mfma_f32_16x16x32_bf16 v[64:67], v[96:99], a[20:23], v[64:67]
  v_mfma_f32_16x16x32_bf16 v[68:71], v[96:99], a[24:27], v[68:71]
  v_mfma_f32_16x16x32_bf16 v[44:47], v[100:103], a[32:35], v[44:47]
  ds_read2_b32 v[72:73], v29 offset0:0 offset1:1
  ds_read2_b32 v[74:75], v29 offset0:2 offset1:3
  ds_read_b32 v76, v29 offset:16
  ds_write_b128 v33, v[40:43]
  v_mfma_f32_16x16x32_bf16 v[48:51], v[100:103], a[36:39], v[48:51]
  s_waitcnt lgkmcnt(9)
  v_alignbit_b32 v104, v85, v84, v32
  s_waitcnt lgkmcnt(8)
  v_alignbit_b32 v105, v86, v85, v32
  v_alignbit_b32 v106, v87, v86, v32
  s_waitcnt lgkmcnt(7)
  v_alignbit_b32 v107, v88, v87, v32
  v_mfma_f32_16x16x32_bf16 v[52:55], v[100:103], a[40:43], v[52:55]
  v_mfma_f32_16x16x32_bf16 v[56:59], v[100:103], a[44:47], v[56:59]
  v_mfma_f32_16x16x32_bf16 v[60:63], v[100:103], a[48:51], v[60:63]
  v_mfma_f32_16x16x32_bf16 v[64:67], v[100:103], a[52:55], v[64:67]
  v_mfma_f32_16x16x32_bf16 v[68:71], v[100:103], a[56:59], v[68:71]
  v_mfma_f32_16x16x32_bf16 v[44:47], v[104:107], a[64:67], v[44:47]
  ds_read2_b32 v[78:79], v29 offset0:16 offset1:17
  ds_read2_b32 v[80:81], v29 offset0:18 offset1:19
  ds_read_b32 v82, v29 offset:80
  v_mfma_f32_16x16x32_bf16 v[48:51], v[104:107], a[68:71], v[48:51]
  s_waitcnt lgkmcnt(9)
  v_alignbit_b32 v108, v91, v90, v32
  s_waitcnt lgkmcnt(8)
  v_alignbit_b32 v109, v92, v91, v32
  v_alignbit_b32 v110, v93, v92, v32
  s_waitcnt lgkmcnt(7)
  v_alignbit_b32 v111, v94, v93, v32
  v_mfma_f32_16x16x32_bf16 v[52:55], v[104:107], a[72:75], v[52:55]
  v_mfma_f32_16x16x32_bf16 v[56:59], v[104:107], a[76:79], v[56:59]
  v_mfma_f32_16x16x32_bf16 v[60:63], v[104:107], a[80:83], v[60:63]
  v_mfma_f32_16x16x32_bf16 v[64:67], v[104:107], a[84:87], v[64:67]
  v_mfma_f32_16x16x32_bf16 v[68:71], v[104:107], a[88:91], v[68:71]
  v_mfma_f32_16x16x32_bf16 v[44:47], v[108:111], a[96:99], v[44:47]
  ds_read2_b32 v[84:85], v29 offset0:32 offset1:33
  ds_read2_b32 v[86:87], v29 offset0:34 offset1:35
  ds_read_b32 v88, v29 offset:144
  v_mfma_f32_16x16x32_bf16 v[48:51], v[108:111], a[100:103], v[48:51]
  s_waitcnt lgkmcnt(9)
  v_alignbit_b32 v96, v73, v72, v32
  s_waitcnt lgkmcnt(8)
  v_alignbit_b32 v97, v74, v73, v32
  v_alignbit_b32 v98, v75, v74, v32
  s_waitcnt lgkmcnt(7)
  v_alignbit_b32 v99, v76, v75, v32
  v_mfma_f32_16x16x32_bf16 v[52:55], v[108:111], a[104:107], v[52:55]
  v_mfma_f32_16x16x32_bf16 v[56:59], v[108:111], a[108:111], v[56:59]
  v_mfma_f32_16x16x32_bf16 v[60:63], v[108:111], a[112:115], v[60:63]
  v_mfma_f32_16x16x32_bf16 v[64:67], v[108:111], a[116:119], v[64:67]
  v_mfma_f32_16x16x32_bf16 v[68:71], v[108:111], a[120:123], v[68:71]
  s_waitcnt vmcnt(0)
  s_barrier
  s_cmp_lg_u32 s4, 7
  s_cbranch_scc1 A_NOPS
  s_and_b32 s62, s2, 7
  s_lshl_b32 s62, s62, 5
  v_mov_b32 v4, s62
  v_mov_b32 v5, 1
  s_mov_b64 exec, 1
  global_atomic_add v4, v5, s[34:35] offset:4 sc1
  s_mov_b64 exec, -1
A_NOPS:
  v_mfma_f32_16x16x32_bf16 v[48:51], v[96:99], a[0:3], v[48:51]
  ds_read2_b32 v[90:91], v29 offset0:48 offset1:49
  ds_read2_b32 v[92:93], v29 offset0:50 offset1:51
  ds_read_b32 v94, v29 offset:208
  v_mfma_f32_16x16x32_bf16 v[52:55], v[96:99], a[4:7], v[52:55]
  s_waitcnt lgkmcnt(8)
  v_alignbit_b32 v100, v79, v78, v32
  s_waitcnt lgkmcnt(7)
  v_alignbit_b32 v101, v80, v79, v32
  v_alignbit_b32 v102, v81, v80, v32
  s_waitcnt lgkmcnt(6)
  v_alignbit_b32 v103, v82, v81, v32
  v_mfma_f32_16x16x32_bf16 v[56:59], v[96:99], a[8:11], v[56:59]
  v_mfma_f32_16x16x32_bf16 v[60:63], v[96:99], a[12:15], v[60:63]
  v_mfma_f32_16x16x32_bf16 v[64:67], v[96:99], a[16:19], v[64:67]
  v_mfma_f32_16x16x32_bf16 v[68:71], v[96:99], a[20:23], v[68:71]
  v_mfma_f32_16x16x32_bf16 v[48:51], v[100:103], a[32:35], v[48:51]
  ds_read2_b32 v[72:73], v29 offset0:128 offset1:129
  ds_read2_b32 v[74:75], v29 offset0:130 offset1:131
  ds_read_b32 v76, v29 offset:528
  ds_write_b128 v33, v[44:47] offset:8192
  v_mfma_f32_16x16x32_bf16 v[52:55], v[100:103], a[36:39], v[52:55]
  s_waitcnt lgkmcnt(9)
  v_alignbit_b32 v104, v85, v84, v32
  s_waitcnt lgkmcnt(8)
  v_alignbit_b32 v105, v86, v85, v32
  v_alignbit_b32 v106, v87, v86, v32
  s_waitcnt lgkmcnt(7)
  v_alignbit_b32 v107, v88, v87, v32
  v_mfma_f32_16x16x32_bf16 v[56:59], v[100:103], a[40:43], v[56:59]
  v_mfma_f32_16x16x32_bf16 v[60:63], v[100:103], a[44:47], v[60:63]
  v_mfma_f32_16x16x32_bf16 v[64:67], v[100:103], a[48:51], v[64:67]
  v_mfma_f32_16x16x32_bf16 v[68:71], v[100:103], a[52:55], v[68:71]
  v_mfma_f32_16x16x32_bf16 v[48:51], v[104:107], a[64:67], v[48:51]
  ds_read2_b32 v[78:79], v29 offset0:144 offset1:145
  ds_read2_b32 v[80:81], v29 offset0:146 offset1:147
  ds_read_b32 v82, v29 offset:592
  v_mfma_f32_16x16x32_bf16 v[52:55], v[104:107], a[68:71], v[52:55]
  s_waitcnt lgkmcnt(9)
  v_alignbit_b32 v108, v91, v90, v32
  s_waitcnt lgkmcnt(8)
  v_alignbit_b32 v109, v92, v91, v32
  v_alignbit_b32 v110, v93, v92, v32
  s_waitcnt lgkmcnt(7)
  v_alignbit_b32 v111, v94, v93, v32
  v_mfma_f32_16x16x32_bf16 v[56:59], v[104:107], a[72:75], v[56:59]
  v_mfma_f32_16x16x32_bf16 v[60:63], v[104:107], a[76:79], v[60:63]
  v_mfma_f32_16x16x32_bf16 v[64:67], v[104:107], a[80:83], v[64:67]
  v_mfma_f32_16x16x32_bf16 v[68:71], v[104:107], a[84:87], v[68:71]
  v_mfma_f32_16x16x32_bf16 v[48:51], v[108:111], a[96:99], v[48:51]
  ds_read2_b32 v[84:85], v29 offset0:160 offset1:161
  ds_read2_b32 v[86:87], v29 offset0:162 offset1:163
  ds_read_b32 v88, v29 offset:656
  v_mfma_f32_16x16x32_bf16 v[52:55], v[108:111], a[100:103], v[52:55]
  s_waitcnt lgkmcnt(9)
  v_alignbit_b32 v96, v73, v72, v32
  s_waitcnt lgkmcnt(8)
  v_alignbit_b32 v97, v74, v73, v32
  v_alignbit_b32 v98, v75, v74, v32
  s_waitcnt lgkmcnt(7)
  v_alignbit_b32 v99, v76, v75, v32
  v_mfma_f32_16x16x32_bf16 v[56:59], v[108:111], a[104:107], v[56:59]
  v_mfma_f32_16x16x32_bf16 v[60:63], v[108:111], a[108:111], v[60:63]
  v_mfma_f32_16x16x32_bf16 v[64:67], v[108:111], a[112:115], v[64:67]
  v_mfma_f32_16x16x32_bf16 v[68:71], v[108:111], a[116:119], v[68:71]
  v_mfma_f32_16x16x32_bf16 v[52:55], v[96:99], a[0:3], v[52:55]
  ds_read2_b32 v[90:91], v29 offset0:176 offset1:177
  ds_read2_b32 v[92:93], v29 offset0:178 offset1:179
  ds_read_b32 v94, v29 offset:720
  v_mfma_f32_16x16x32_bf16 v[56:59], v[96:99], a[4:7], v[56:59]
  s_waitcnt lgkmcnt(8)
  v_alignbit_b32 v100, v79, v78, v32
  s_waitcnt lgkmcnt(7)
  v_alignbit_b32 v101, v80, v79, v32
  v_alignbit_b32 v102, v81, v80, v32
  s_waitcnt lgkmcnt(6)
  v_alignbit_b32 v103, v82, v81, v32
  v_mfma_f32_16x16x32_bf16 v[60:63], v[96:99], a[8:11], v[60:63]
  v_mfma_f32_16x16x32_bf16 v[64:67], v[96:99], a[12:15], v[64:67]
  v_mfma_f32_16x16x32_bf16 v[68:71], v[96:99], a[16:19], v[68:71]
  v_mfma_f32_16x16x32_bf16 v[52:55], v[100:103], a[32:35], v[52:55]
  ds_read2_b32 v[72:73], v30 offset0:0 offset1:1
  ds_read2_b32 v[74:75], v30 offset0:2 offset1:3
  ds_read_b32 v76, v30 offset:16
  ds_write_b128 v33, v[48:51] offset:16384
  v_mfma_f32_16x16x32_bf16 v[56:59], v[100:103], a[36:39], v[56:59]
  s_waitcnt lgkmcnt(9)
  v_alignbit_b32 v104, v85, v84, v32
  s_waitcnt lgkmcnt(8)
  v_alignbit_b32 v105, v86, v85, v32
  v_alignbit_b32 v106, v87, v86, v32
  s_waitcnt lgkmcnt(7)
  v_alignbit_b32 v107, v88, v87, v32
  v_mfma_f32_16x16x32_bf16 v[60:63], v[100:103], a[40:43], v[60:63]
  v_mfma_f32_16x16x32_bf16 v[64:67], v[100:103], a[44:47], v[64:67]
  v_mfma_f32_16x16x32_bf16 v[68:71], v[100:103], a[48:51], v[68:71]
  v_mfma_f32_16x16x32_bf16 v[52:55], v[104:107], a[64:67], v[52:55]
  ds_read2_b32 v[78:79], v30 offset0:16 offset1:17
  ds_read2_b32 v[80:81], v30 offset0:18 offset1:19
  ds_read_b32 v82, v30 offset:80
  v_mfma_f32_16x16x32_bf16 v[56:59], v[104:107], a[68:71], v[56:59]
  s_waitcnt lgkmcnt(9)
  v_alignbit_b32 v108, v91, v90, v32
  s_waitcnt lgkmcnt(8)
  v_alignbit_b32 v109, v92, v91, v32
  v_alignbit_b32 v110, v93, v92, v32
  s_waitcnt lgkmcnt(7)
  v_alignbit_b32 v111, v94, v93, v32
  v_mfma_f32_16x16x32_bf16 v[60:63], v[104:107], a[72:75], v[60:63]
  v_mfma_f32_16x16x32_bf16 v[64:67], v[104:107], a[76:79], v[64:67]
  v_mfma_f32_16x16x32_bf16 v[68:71], v[104:107], a[80:83], v[68:71]
  v_mfma_f32_16x16x32_bf16 v[52:55], v[108:111], a[96:99], v[52:55]
  ds_read2_b32 v[84:85], v30 offset0:32 offset1:33
  ds_read2_b32 v[86:87], v30 offset0:34 offset1:35
  ds_read_b32 v88, v30 offset:144
  v_mfma_f32_16x16x32_bf16 v[56:59], v[108:111], a[100:103], v[56:59]
  s_waitcnt lgkmcnt(9)
  v_alignbit_b32 v96, v73, v72, v32
  s_waitcnt lgkmcnt(8)
  v_alignbit_b32 v97, v74, v73, v32
  v_alignbit_b32 v98, v75, v74, v32
  s_waitcnt lgkmcnt(7)
  v_alignbit_b32 v99, v76, v75, v32
  v_mfma_f32_16x16x32_bf16 v[60:63], v[108:111], a[104:107], v[60:63]
  v_mfma_f32_16x16x32_bf16 v[64:67], v[108:111], a[108:111], v[64:67]
  v_mfma_f32_16x16x32_bf16 v[68:71], v[108:111], a[112:115], v[68:71]
  v_mfma_f32_16x16x32_bf16 v[56:59], v[96:99], a[0:3], v[56:59]
  ds_read2_b32 v[90:91], v30 offset0:48 offset1:49
  ds_read2_b32 v[92:93], v30 offset0:50 offset1:51
  ds_read_b32 v94, v30 offset:208
  v_mfma_f32_16x16x32_bf16 v[60:63], v[96:99], a[4:7], v[60:63]
  s_waitcnt lgkmcnt(8)
  v_alignbit_b32 v100, v79, v78, v32
  s_waitcnt lgkmcnt(7)
  v_alignbit_b32 v101, v80, v79, v32
  v_alignbit_b32 v102, v81, v80, v32
  s_waitcnt lgkmcnt(6)
  v_alignbit_b32 v103, v82, v81, v32
  v_mfma_f32_16x16x32_bf16 v[64:67], v[96:99], a[8:11], v[64:67]
  v_mfma_f32_16x16x32_bf16 v[68:71], v[96:99], a[12:15], v[68:71]
  v_mfma_f32_16x16x32_bf16 v[56:59], v[100:103], a[32:35], v[56:59]
  ds_read2_b32 v[72:73], v30 offset0:128 offset1:129
  ds_read2_b32 v[74:75], v30 offset0:130 offset1:131
  ds_read_b32 v76, v30 offset:528
  ds_write_b128 v33, v[52:55] offset:24576
  v_mfma_f32_16x16x32_bf16 v[60:63], v[100:103], a[36:39], v[60:63]
  s_waitcnt lgkmcnt(9)
  v_alignbit_b32 v104, v85, v84, v32
  s_waitcnt lgkmcnt(8)
  v_alignbit_b32 v105, v86, v85, v32
  v_alignbit_b32 v106, v87, v86, v32
  s_waitcnt lgkmcnt(7)
  v_alignbit_b32 v107, v88, v87, v32
  v_mfma_f32_16x16x32_bf16 v[64:67], v[100:103], a[40:43], v[64:67]
  v_mfma_f32_16x16x32_bf16 v[68:71], v[100:103], a[44:47], v[68:71]
  v_mfma_f32_16x16x32_bf16 v[56:59], v[104:107], a[64:67], v[56:59]
  ds_read2_b32 v[78:79], v30 offset0:144 offset1:145
  ds_read2_b32 v[80:81], v30 offset0:146 offset1:147
  ds_read_b32 v82, v30 offset:592
  v_mfma_f32_16x16x32_bf16 v[60:63], v[104:107], a[68:71], v[60:63]
  s_waitcnt lgkmcnt(9)
  v_alignbit_b32 v108, v91, v90, v32
  s_waitcnt lgkmcnt(8)
  v_alignbit_b32 v109, v92, v91, v32
  v_alignbit_b32 v110, v93, v92, v32
  s_waitcnt lgkmcnt(7)
  v_alignbit_b32 v111, v94, v93, v32
  v_mfma_f32_16x16x32_bf16 v[64:67], v[104:107], a[72:75], v[64:67]
  v_mfma_f32_16x16x32_bf16 v[68:71], v[104:107], a[76:79], v[68:71]
  v_mfma_f32_16x16x32_bf16 v[56:59], v[108:111], a[96:99], v[56:59]
  ds_read2_b32 v[84:85], v30 offset0:160 offset1:161
  ds_read2_b32 v[86:87], v30 offset0:162 offset1:163
  ds_read_b32 v88, v30 offset:656
  v_mfma_f32_16x16x32_bf16 v[60:63], v[108:111], a[100:103], v[60:63]
  s_waitcnt lgkmcnt(9)
  v_alignbit_b32 v96, v73, v72, v32
  s_waitcnt lgkmcnt(8)
  v_alignbit_b32 v97, v74, v73, v32
  v_alignbit_b32 v98, v75, v74, v32
  s_waitcnt lgkmcnt(7)
  v_alignbit_b32 v99, v76, v75, v32
  v_mfma_f32_16x16x32_bf16 v[64:67], v[108:111], a[104:107], v[64:67]
  v_mfma_f32_16x16x32_bf16 v[68:71], v[108:111], a[108:111], v[68:71]
  v_mfma_f32_16x16x32_bf16 v[60:63], v[96:99], a[0:3], v[60:63]
  ds_read2_b32 v[90:91], v30 offset0:176 offset1:177
  ds_read2_b32 v[92:93], v30 offset0:178 offset1:179
  ds_read_b32 v94, v30 offset:720
  v_mfma_f32_16x16x32_bf16 v[64:67], v[96:99], a[4:7], v[64:67]
  s_waitcnt lgkmcnt(8)
  v_alignbit_b32 v100, v79, v78, v32
  s_waitcnt lgkmcnt(7)
  v_alignbit_b32 v101, v80, v79, v32
  v_alignbit_b32 v102, v81, v80, v32
  s_waitcnt lgkmcnt(6)
  v_alignbit_b32 v103, v82, v81, v32
  v_mfma_f32_16x16x32_bf16 v[68:71], v[96:99], a[8:11], v[68:71]
  s_nop 0
  v_mfma_f32_16x16x32_bf16 v[60:63], v[100:103], a[32:35], v[60:63]
  ds_read2_b32 v[72:73], v31 offset0:0 offset1:1
  ds_read2_b32 v[74:75], v31 offset0:2 offset1:3
  ds_read_b32 v76, v31 offset:16
  ds_write_b128 v33, v[56:59] offset:32768
  v_mfma_f32_16x16x32_bf16 v[64:67], v[100:103], a[36:39], v[64:67]
  s_waitcnt lgkmcnt(9)
  v_alignbit_b32 v104, v85, v84, v32
  s_waitcnt lgkmcnt(8)
  v_alignbit_b32 v105, v86, v85, v32
  v_alignbit_b32 v106, v87, v86, v32
  s_waitcnt lgkmcnt(7)
  v_alignbit_b32 v107, v88, v87, v32
  v_mfma_f32_16x16x32_bf16 v[68:71], v[100:103], a[40:43], v[68:71]
  s_nop 0
  v_mfma_f32_16x16x32_bf16 v[60:63], v[104:107], a[64:67], v[60:63]
  ds_read2_b32 v[78:79], v31 offset0:16 offset1:17
  ds_read2_b32 v[80:81], v31 offset0:18 offset1:19
  ds_read_b32 v82, v31 offset:80
  v_mfma_f32_16x16x32_bf16 v[64:67], v[104:107], a[68:71], v[64:67]
  s_waitcnt lgkmcnt(9)
  v_alignbit_b32 v108, v91, v90, v32
  s_waitcnt lgkmcnt(8)
  v_alignbit_b32 v109, v92, v91, v32
  v_alignbit_b32 v110, v93, v92, v32
  s_waitcnt lgkmcnt(7)
  v_alignbit_b32 v111, v94, v93, v32
  v_mfma_f32_16x16x32_bf16 v[68:71], v[104:107], a[72:75], v[68:71]
  s_nop 0
  v_mfma_f32_16x16x32_bf16 v[60:63], v[108:111], a[96:99], v[60:63]
  ds_read2_b32 v[84:85], v31 offset0:32 offset1:33
  ds_read2_b32 v[86:87], v31 offset0:34 offset1:35
  ds_read_b32 v88, v31 offset:144
  v_mfma_f32_16x16x32_bf16 v[64:67], v[108:111], a[100:103], v[64:67]
  s_waitcnt lgkmcnt(9)
  v_alignbit_b32 v96, v73, v72, v32
  s_waitcnt lgkmcnt(8)
  v_alignbit_b32 v97, v74, v73, v32
  v_alignbit_b32 v98, v75, v74, v32
  s_waitcnt lgkmcnt(7)
  v_alignbit_b32 v99, v76, v75, v32
  v_mfma_f32_16x16x32_bf16 v[68:71], v[108:111], a[104:107], v[68:71]
  s_nop 0
  v_mfma_f32_16x16x32_bf16 v[64:67], v[96:99], a[0:3], v[64:67]
  ds_read2_b32 v[90:91], v31 offset0:48 offset1:49
  ds_read2_b32 v[92:93], v31 offset0:50 offset1:51
  ds_read_b32 v94, v31 offset:208
  v_mfma_f32_16x16x32_bf16 v[68:71], v[96:99], a[4:7], v[68:71]
  s_waitcnt lgkmcnt(8)
  v_alignbit_b32 v100, v79, v78, v32
  s_waitcnt lgkmcnt(7)
  v_alignbit_b32 v101, v80, v79, v32
  v_alignbit_b32 v102, v81, v80, v32
  s_waitcnt lgkmcnt(6)
  v_alignbit_b32 v103, v82, v81, v32
  s_nop 1
  v_mfma_f32_16x16x32_bf16 v[64:67], v[100:103], a[32:35], v[64:67]
  ds_read2_b32 v[72:73], v31 offset0:128 offset1:129
  ds_read2_b32 v[74:75], v31 offset0:130 offset1:131
  ds_read_b32 v76, v31 offset:528
  ds_write_b128 v33, v[60:63] offset:40960
  v_mfma_f32_16x16x32_bf16 v[68:71], v[100:103], a[36:39], v[68:71]
  s_waitcnt lgkmcnt(9)
  v_alignbit_b32 v104, v85, v84, v32
  s_waitcnt lgkmcnt(8)
  v_alignbit_b32 v105, v86, v85, v32
  v_alignbit_b32 v106, v87, v86, v32
  s_waitcnt lgkmcnt(7)
  v_alignbit_b32 v107, v88, v87, v32
  s_nop 1
  v_mfma_f32_16x16x32_bf16 v[64:67], v[104:107], a[64:67], v[64:67]
  ds_read2_b32 v[78:79], v31 offset0:144 offset1:145
  ds_read2_b32 v[80:81], v31 offset0:146 offset1:147
  ds_read_b32 v82, v31 offset:592
  v_mfma_f32_16x16x32_bf16 v[68:71], v[104:107], a[68:71], v[68:71]
  s_waitcnt lgkmcnt(9)
  v_alignbit_b32 v108, v91, v90, v32
  s_waitcnt lgkmcnt(8)
  v_alignbit_b32 v109, v92, v91, v32
  v_alignbit_b32 v110, v93, v92, v32
  s_waitcnt lgkmcnt(7)
  v_alignbit_b32 v111, v94, v93, v32
  s_nop 1
  v_mfma_f32_16x16x32_bf16 v[64:67], v[108:111], a[96:99], v[64:67]
  ds_read2_b32 v[84:85], v31 offset0:160 offset1:161
  ds_read2_b32 v[86:87], v31 offset0:162 offset1:163
  ds_read_b32 v88, v31 offset:656
  v_mfma_f32_16x16x32_bf16 v[68:71], v[108:111], a[100:103], v[68:71]
  s_waitcnt lgkmcnt(9)
  v_alignbit_b32 v96, v73, v72, v32
  s_waitcnt lgkmcnt(8)
  v_alignbit_b32 v97, v74, v73, v32
  v_alignbit_b32 v98, v75, v74, v32
  s_waitcnt lgkmcnt(7)
  v_alignbit_b32 v99, v76, v75, v32
  s_nop 1
  v_mfma_f32_16x16x32_bf16 v[68:71], v[96:99], a[0:3], v[68:71]
  ds_read2_b32 v[90:91], v31 offset0:176 offset1:177
  ds_read2_b32 v[92:93], v31 offset0:178 offset1:179
  ds_read_b32 v94, v31 offset:720
  s_waitcnt lgkmcnt(8)
  v_alignbit_b32 v100, v79, v78, v32
  s_waitcnt lgkmcnt(7)
  v_alignbit_b32 v101, v80, v79, v32
  v_alignbit_b32 v102, v81, v80, v32
  s_waitcnt lgkmcnt(6)
  v_alignbit_b32 v103, v82, v81, v32
  s_nop 1
  v_mfma_f32_16x16x32_bf16 v[68:71], v[100:103], a[32:35], v[68:71]
  s_waitcnt lgkmcnt(5)
  v_alignbit_b32 v104, v85, v84, v32
  s_waitcnt lgkmcnt(4)
  v_alignbit_b32 v105, v86, v85, v32
  v_alignbit_b32 v106, v87, v86, v32
  s_waitcnt lgkmcnt(3)
  v_alignbit_b32 v107, v88, v87, v32
  ds_write_b128 v33, v[64:67] offset:49152
  s_nop 0
  v_mfma_f32_16x16x32_bf16 v[68:71], v[104:107], a[64:67], v[68:71]
  s_waitcnt lgkmcnt(3)
  v_alignbit_b32 v108, v91, v90, v32
  s_waitcnt lgkmcnt(2)
  v_alignbit_b32 v109, v92, v91, v32
  v_alignbit_b32 v110, v93, v92, v32
  s_waitcnt lgkmcnt(1)
  v_alignbit_b32 v111, v94, v93, v32
  s_nop 1
  v_mfma_f32_16x16x32_bf16 v[68:71], v[108:111], a[96:99], v[68:71]
  s_cmp_lg_u32 s4, 0
  s_cbranch_scc1 A_PCI
  s_mov_b64 exec, 0xff
  global_load_dword v125, v124, s[34:35] offset:4 sc1
  s_mov_b64 exec, -1
A_PCI:
  s_nop 5
  ds_write_b128 v33, v[68:71] offset:57344
  s_waitcnt lgkmcnt(0)
  s_barrier
  ds_read_b64 v[40:41], v35
  ds_read_b64 v[42:43], v35 offset:1024
  ds_read_b64 v[44:45], v35 offset:2048
  ds_read_b64 v[46:47], v35 offset:3072
  ds_read_b64 v[48:49], v35 offset:4096
  ds_read_b64 v[50:51], v35 offset:5120
  ds_read_b64 v[52:53], v35 offset:6144
  ds_read_b64 v[54:55], v35 offset:7168
  ds_read_b64 v[56:57], v35 offset:512
  ds_read_b64 v[58:59], v35 offset:1536
  ds_read_b64 v[60:61], v35 offset:2560
  ds_read_b64 v[62:63], v35 offset:3584
  ds_read_b64 v[64:65], v35 offset:4608
  ds_read_b64 v[66:67], v35 offset:5632
  ds_read_b64 v[68:69], v35 offset:6656
  ds_read_b64 v[70:71], v35 offset:7680
  s_waitcnt lgkmcnt(14)
  v_pk_add_f32 v[40:41], v[40:41], v[42:43]
  s_waitcnt lgkmcnt(12)
  v_pk_add_f32 v[44:45], v[44:45], v[46:47]
  s_waitcnt lgkmcnt(10)
  v_pk_add_f32 v[48:49], v[48:49], v[50:51]
  s_waitcnt lgkmcnt(8)
  v_pk_add_f32 v[52:53], v[52:53], v[54:55]
  v_cvt_pk_bf16_f32 v72, v40, v44
  v_cvt_pk_bf16_f32 v74, v41, v45
  v_cvt_pk_bf16_f32 v73, v48, v52
  v_cvt_pk_bf16_f32 v75, v49, v53
  v_min_u32 v72, -2, v72
  v_min_u32 v74, -2, v74
  buffer_store_dwordx4 v[72:75], v116, s[48:51], s17 offen sc1
  s_waitcnt lgkmcnt(6)
  v_pk_add_f32 v[56:57], v[56:57], v[58:59]
  s_waitcnt lgkmcnt(4)
  v_pk_add_f32 v[60:61], v[60:61], v[62:63]
  s_waitcnt lgkmcnt(2)
  v_pk_add_f32 v[64:65], v[64:65], v[66:67]
  s_waitcnt lgkmcnt(0)
  v_pk_add_f32 v[68:69], v[68:69], v[70:71]
  v_cvt_pk_bf16_f32 v76, v56, v60
  v_cvt_pk_bf16_f32 v78, v57, v61
  v_cvt_pk_bf16_f32 v77, v64, v68
  v_cvt_pk_bf16_f32 v79, v65, v69
  v_min_u32 v76, -2, v76
  v_min_u32 v78, -2, v78
  buffer_store_dwordx4 v[76:79], v116, s[48:51], s17 offen offset:1024 sc1
TAIL:
  s_mov_b32 s56, s32
  s_and_b32 s57, s33, 0xffff
  s_mov_b32 s58, 0x200000
  s_mov_b32 s59, 0x20000
  s_cmp_lg_u32 s4, 0
  s_cbranch_scc1 T_PCX
  s_waitcnt vmcnt(2)
T_PC2:
  s_mov_b64 exec, 0xff
  v_cmp_ne_u32 vcc, 32, v125
  s_cbranch_vccnz T_PCL
T_PCOK:
  s_mov_b64 exec, -1
T_PCX:
  s_barrier
  buffer_load_dword v8, v119, s[48:51], s15 offen sc1
  buffer_load_dword v9, v119, s[48:51], s15 offen offset:128 sc1
  buffer_load_dword v10, v119, s[48:51], s15 offen offset:256 sc1
  buffer_load_dword v11, v119, s[48:51], s15 offen offset:384 sc1
  buffer_load_dword v16, v117, s[48:51], s12 offen sc1
T_WOA:
  ds_read_b64_tr_b16 a[28:29], v112 offset:0
  ds_read_b64_tr_b16 a[30:31], v112 offset:256
  ds_read_b64_tr_b16 a[60:61], v113 offset:0
  ds_read_b64_tr_b16 a[62:63], v113 offset:256
  ds_read_b64_tr_b16 a[92:93], v114 offset:0
  ds_read_b64_tr_b16 a[94:95], v114 offset:256
  ds_read_b64_tr_b16 a[124:125], v115 offset:0
  ds_read_b64_tr_b16 a[126:127], v115 offset:256
  ds_read_b64_tr_b16 a[20:21], v112 offset:1024
  ds_read_b64_tr_b16 a[22:23], v112 offset:1280
  ds_read_b64_tr_b16 a[52:53], v113 offset:1024
  ds_read_b64_tr_b16 a[54:55], v113 offset:1280
  ds_read_b64_tr_b16 a[84:85], v114 offset:1024
  ds_read_b64_tr_b16 a[86:87], v114 offset:1280
  ds_read_b64_tr_b16 a[116:117], v115 offset:1024
  ds_read_b64_tr_b16 a[118:119], v115 offset:1280
  ds_read_b64_tr_b16 a[12:13], v112 offset:2048
  ds_read_b64_tr_b16 a[14:15], v112 offset:2304
  ds_read_b64_tr_b16 a[44:45], v113 offset:2048
  ds_read_b64_tr_b16 a[46:47], v113 offset:2304
  ds_read_b64_tr_b16 a[76:77], v114 offset:2048
  ds_read_b64_tr_b16 a[78:79], v114 offset:2304
  ds_read_b64_tr_b16 a[108:109], v115 offset:2048
  ds_read_b64_tr_b16 a[110:111], v115 offset:2304
  ds_read_b64_tr_b16 a[4:5], v112 offset:3072
  ds_read_b64_tr_b16 a[6:7], v112 offset:3328
  ds_read_b64_tr_b16 a[36:37], v113 offset:3072
  ds_read_b64_tr_b16 a[38:39], v113 offset:3328
  ds_read_b64_tr_b16 a[68:69], v114 offset:3072
  ds_read_b64_tr_b16 a[70:71], v114 offset:3328
  ds_read_b64_tr_b16 a[100:101], v115 offset:3072
  ds_read_b64_tr_b16 a[102:103], v115 offset:3328
  ds_read_b64_tr_b16 a[24:25], v112 offset:16384
  ds_read_b64_tr_b16 a[26:27], v112 offset:16640
  ds_read_b64_tr_b16 a[56:57], v113 offset:16384
  ds_read_b64_tr_b16 a[58:59], v113 offset:16640
  ds_read_b64_tr_b16 a[88:89], v114 offset:16384
  ds_read_b64_tr_b16 a[90:91], v114 offset:16640
  ds_read_b64_tr_b16 a[120:121], v115 offset:16384
  ds_read_b64_tr_b16 a[122:123], v115 offset:16640
  ds_read_b64_tr_b16 a[16:17], v112 offset:17408
  ds_read_b64_tr_b16 a[18:19], v112 offset:17664
  ds_read_b64_tr_b16 a[48:49], v113 offset:17408
  ds_read_b64_tr_b16 a[50:51], v113 offset:17664
  ds_read_b64_tr_b16 a[80:81], v114 offset:17408
  ds_read_b64_tr_b16 a[82:83], v114 offset:17664
  ds_read_b64_tr_b16 a[112:113], v115 offset:17408
  ds_read_b64_tr_b16 a[114:115], v115 offset:17664
  ds_read_b64_tr_b16 a[8:9], v112 offset:18432
  ds_read_b64_tr_b16 a[10:11], v112 offset:18688
  ds_read_b64_tr_b16 a[40:41], v113 offset:18432
  ds_read_b64_tr_b16 a[42:43], v113 offset:18688
  ds_read_b64_tr_b16 a[72:73], v114 offset:18432
  ds_read_b64_tr_b16 a[74:75], v114 offset:18688
  ds_read_b64_tr_b16 a[104:105], v115 offset:18432
  ds_read_b64_tr_b16 a[106:107], v115 offset:18688
  ds_read_b64_tr_b16 a[0:1], v112 offset:19456
  ds_read_b64_tr_b16 a[2:3], v112 offset:19712
  ds_read_b64_tr_b16 a[32:33], v113 offset:19456
  ds_read_b64_tr_b16 a[34:35], v113 offset:19712
  ds_read_b64_tr_b16 a[64:65], v114 offset:19456
  ds_read_b64_tr_b16 a[66:67], v114 offset:19712
  ds_read_b64_tr_b16 a[96:97], v115 offset:19456
  ds_read_b64_tr_b16 a[98:99], v115 offset:19712
  s_branch T_PROB1
T_PROBE:
  s_waitcnt vmcnt(0)
  buffer_load_dword v16, v117, s[48:51], s12 offen sc1
T_PROB1:
  s_waitcnt vmcnt(0)
  v_cmp_ne_u32 vcc, -1, v16
  s_cbranch_vccz T_PROBE
T_PROX:
  buffer_load_dwordx2 v[12:13], v118, s[48:51], s14 offen sc1
  buffer_load_dwordx2 v[14:15], v118, s[48:51], s20 offen sc1
  buffer_load_dwordx4 v[32:35], v116, s[48:51], s12 offen sc1
  buffer_load_dwordx4 v[36:39], v116, s[48:51], s12 offen offset:2048 sc1
  buffer_load_dwordx4 v[40:43], v116, s[48:51], s13 offen sc1
  buffer_load_dwordx4 v[44:47], v116, s[48:51], s13 offen offset:2048 sc1
  buffer_load_dwordx4 v[48:51], v116, s[48:51], s12 offen offset:1024 sc1
  buffer_load_dwordx4 v[52:55], v116, s[48:51], s12 offen offset:3072 sc1
  buffer_load_dwordx4 v[56:59], v116, s[48:51], s13 offen offset:1024 sc1
  buffer_load_dwordx4 v[60:63], v116, s[48:51], s13 offen offset:3072 sc1
  v_add_f32 v8, v8, v9
  v_add_f32 v10, v10, v11
  v_add_f32 v8, v8, v10
  v_mov_b32 v9, v8
  s_nop 1
  v_permlane32_swap_b32 v8, v9
  v_add_f32 v8, v8, v9
  v_mov_b32 v9, v8
  s_nop 1
  v_permlane16_swap_b32 v8, v9
  v_add_f32 v8, v8, v9
  v_cvt_pk_bf16_f32 v8, v8, v8
  v_and_b32 v8, 0xffff0000, v8
  v_mul_f32 v8, 0xbfb8aa3b, v8
  v_exp_f32 v8, v8
  s_nop 0
  v_add_f32 v8, 1.0, v8
  v_rcp_f32 v8, v8
  s_nop 0
  v_cvt_pk_bf16_f32 v18, v8, v8
  v_and_b32 v18, 0xffff0000, v18
  v_sub_f32 v20, 1.0, v18
  v_cvt_pk_bf16_f32 v20, v20, v20
  v_and_b32 v20, 0xffff0000, v20
  s_waitcnt vmcnt(8)
  v_max_u32 v16, v12, v14
  v_cmp_eq_u32 s[62:63], -1, v16
  v_lshlrev_b32 v80, 16, v12
  v_and_b32 v81, 0xffff0000, v12
  v_lshlrev_b32 v82, 16, v13
  v_and_b32 v83, 0xffff0000, v13
  v_lshlrev_b32 v84, 16, v14
  v_and_b32 v85, 0xffff0000, v14
  v_lshlrev_b32 v86, 16, v15
  v_and_b32 v87, 0xffff0000, v15
  v_mul_f32 v80, v80, v18
  v_mul_f32 v81, v81, v18
  v_mul_f32 v82, v82, v18
  v_mul_f32 v83, v83, v18
  v_mul_f32 v84, v84, v18
  v_mul_f32 v85, v85, v18
  v_mul_f32 v86, v86, v18
  v_mul_f32 v87, v87, v18
  s_waitcnt lgkmcnt(0)
T_CK0:
  s_waitcnt vmcnt(7)
  v_cmp_eq_u32 vcc, -1, v32
  s_cbranch_vccnz T_RT0
T_OK0:
  v_mfma_f32_16x16x32_bf16 v[64:67], a[28:31], v[32:35], 0
  v_mfma_f32_16x16x32_bf16 v[68:71], a[60:63], v[32:35], 0
  v_mfma_f32_16x16x32_bf16 v[72:75], a[92:95], v[32:35], 0
  v_mfma_f32_16x16x32_bf16 v[76:79], a[124:127], v[32:35], 0
T_CK1:
  s_waitcnt vmcnt(6)
  v_cmp_eq_u32 vcc, -1, v36
  s_cbranch_vccnz T_RT1
T_OK1:
  v_mfma_f32_16x16x32_bf16 v[64:67], a[20:23], v[36:39], v[64:67]
  v_mfma_f32_16x16x32_bf16 v[68:71], a[52:55], v[36:39], v[68:71]
  v_mfma_f32_16x16x32_bf16 v[72:75], a[84:87], v[36:39], v[72:75]
  v_mfma_f32_16x16x32_bf16 v[76:79], a[116:119], v[36:39], v[76:79]
T_CK2:
  s_waitcnt vmcnt(5)
  v_cmp_eq_u32 vcc, -1, v40
  s_cbranch_vccnz T_RT2
T_OK2:
  v_mfma_f32_16x16x32_bf16 v[64:67], a[12:15], v[40:43], v[64:67]
  v_mfma_f32_16x16x32_bf16 v[68:71], a[44:47], v[40:43], v[68:71]
  v_mfma_f32_16x16x32_bf16 v[72:75], a[76:79], v[40:43], v[72:75]
  v_mfma_f32_16x16x32_bf16 v[76:79], a[108:111], v[40:43], v[76:79]
T_CK3:
  s_waitcnt vmcnt(4)
  v_cmp_eq_u32 vcc, -1, v44
  s_cbranch_vccnz T_RT3
T_OK3:
  v_mfma_f32_16x16x32_bf16 v[64:67], a[4:7], v[44:47], v[64:67]
  v_mfma_f32_16x16x32_bf16 v[68:71], a[36:39], v[44:47], v[68:71]
  v_mfma_f32_16x16x32_bf16 v[72:75], a[68:71], v[44:47], v[72:75]
  v_mfma_f32_16x16x32_bf16 v[76:79], a[100:103], v[44:47], v[76:79]
T_CK4:
  s_waitcnt vmcnt(3)
  v_cmp_eq_u32 vcc, -1, v48
  s_cbranch_vccnz T_RT4
T_OK4:
  v_mfma_f32_16x16x32_bf16 v[64:67], a[24:27], v[48:51], v[64:67]
  v_mfma_f32_16x16x32_bf16 v[68:71], a[56:59], v[48:51], v[68:71]
  v_mfma_f32_16x16x32_bf16 v[72:75], a[88:91], v[48:51], v[72:75]
  v_mfma_f32_16x16x32_bf16 v[76:79], a[120:123], v[48:51], v[76:79]
T_CK5:
  s_waitcnt vmcnt(2)
  v_cmp_eq_u32 vcc, -1, v52
  s_cbranch_vccnz T_RT5
T_OK5:
  v_mfma_f32_16x16x32_bf16 v[64:67], a[16:19], v[52:55], v[64:67]
  v_mfma_f32_16x16x32_bf16 v[68:71], a[48:51], v[52:55], v[68:71]
  v_mfma_f32_16x16x32_bf16 v[72:75], a[80:83], v[52:55], v[72:75]
  v_mfma_f32_16x16x32_bf16 v[76:79], a[112:115], v[52:55], v[76:79]
T_CK6:
  s_waitcnt vmcnt(1)
  v_cmp_eq_u32 vcc, -1, v56
  s_cbranch_vccnz T_RT6
T_OK6:
  v_mfma_f32_16x16x32_bf16 v[64:67], a[8:11], v[56:59], v[64:67]
  v_mfma_f32_16x16x32_bf16 v[68:71], a[40:43], v[56:59], v[68:71]
T_CK7:
  s_waitcnt vmcnt(0)
  v_cmp_eq_u32 vcc, -1, v60
  s_cbranch_vccnz T_RT7
T_OK7:
  v_mfma_f32_16x16x32_bf16 v[64:67], a[0:3], v[60:63], v[64:67]
  v_mfma_f32_16x16x32_bf16 v[68:71], a[32:35], v[60:63], v[68:71]
  v_mfma_f32_16x16x32_bf16 v[72:75], a[72:75], v[56:59], v[72:75]
  v_mfma_f32_16x16x32_bf16 v[76:79], a[104:107], v[56:59], v[76:79]
  v_mfma_f32_16x16x32_bf16 v[72:75], a[64:67], v[60:63], v[72:75]
  v_mfma_f32_16x16x32_bf16 v[76:79], a[96:99], v[60:63], v[76:79]
  s_nop 2
  ds_write_b128 v122, v[64:67]
  ds_write_b128 v122, v[68:71] offset:1024
  s_cmp_lg_u64 s[62:63], 0
  s_cbranch_scc1 T_ART
T_AOK:
  v_fmac_f32 v80, v72, v20
  v_fmac_f32 v81, v73, v20
  v_fmac_f32 v82, v74, v20
  v_fmac_f32 v83, v75, v20
  v_fmac_f32 v84, v76, v20
  v_fmac_f32 v85, v77, v20
  v_fmac_f32 v86, v78, v20
  v_fmac_f32 v87, v79, v20
  s_waitcnt lgkmcnt(0)
  s_barrier
  ds_read_b128 v[88:91], v123
  ds_read_b128 v[92:95], v123 offset:1024
  s_waitcnt lgkmcnt(1)
  v_fmac_f32 v80, v88, v20
  v_fmac_f32 v81, v89, v20
  v_cvt_pk_bf16_f32 v96, v80, v81
  v_fmac_f32 v82, v90, v20
  v_fmac_f32 v83, v91, v20
  v_cvt_pk_bf16_f32 v97, v82, v83
  s_waitcnt lgkmcnt(0)
  v_fmac_f32 v84, v92, v20
  v_fmac_f32 v85, v93, v20
  v_cvt_pk_bf16_f32 v98, v84, v85
  v_fmac_f32 v86, v94, v20
  v_fmac_f32 v87, v95, v20
  v_cvt_pk_bf16_f32 v99, v86, v87
  v_permlane16_swap_b32 v96, v98
  s_nop 0
  v_permlane16_swap_b32 v97, v99
  buffer_store_dwordx4 v[96:99], v120, s[56:59], s16 offen
  s_endpgm
T_PCL:
T_PCL1:
  global_load_dword v125, v124, s[34:35] offset:4 sc1
  s_waitcnt vmcnt(0)
  v_cmp_ne_u32 vcc, 32, v125
  s_cbranch_vccnz T_PCL1
  s_branch T_PCOK
T_RT0:
  buffer_load_dwordx4 v[32:35], v116, s[48:51], s12 offen sc1
  buffer_load_dwordx4 v[36:39], v116, s[48:51], s12 offen offset:2048 sc1
  buffer_load_dwordx4 v[40:43], v116, s[48:51], s13 offen sc1
  buffer_load_dwordx4 v[44:47], v116, s[48:51], s13 offen offset:2048 sc1
  buffer_load_dwordx4 v[48:51], v116, s[48:51], s12 offen offset:1024 sc1
  buffer_load_dwordx4 v[52:55], v116, s[48:51], s12 offen offset:3072 sc1
  buffer_load_dwordx4 v[56:59], v116, s[48:51], s13 offen offset:1024 sc1
  buffer_load_dwordx4 v[60:63], v116, s[48:51], s13 offen offset:3072 sc1
  s_branch T_CK0
T_RT1:
  buffer_load_dwordx4 v[36:39], v116, s[48:51], s12 offen offset:2048 sc1
  buffer_load_dwordx4 v[40:43], v116, s[48:51], s13 offen sc1
  buffer_load_dwordx4 v[44:47], v116, s[48:51], s13 offen offset:2048 sc1
  buffer_load_dwordx4 v[48:51], v116, s[48:51], s12 offen offset:1024 sc1
  buffer_load_dwordx4 v[52:55], v116, s[48:51], s12 offen offset:3072 sc1
  buffer_load_dwordx4 v[56:59], v116, s[48:51], s13 offen offset:1024 sc1
  buffer_load_dwordx4 v[60:63], v116, s[48:51], s13 offen offset:3072 sc1
  s_branch T_CK1
T_RT2:
  buffer_load_dwordx4 v[40:43], v116, s[48:51], s13 offen sc1
  buffer_load_dwordx4 v[44:47], v116, s[48:51], s13 offen offset:2048 sc1
  buffer_load_dwordx4 v[48:51], v116, s[48:51], s12 offen offset:1024 sc1
  buffer_load_dwordx4 v[52:55], v116, s[48:51], s12 offen offset:3072 sc1
  buffer_load_dwordx4 v[56:59], v116, s[48:51], s13 offen offset:1024 sc1
  buffer_load_dwordx4 v[60:63], v116, s[48:51], s13 offen offset:3072 sc1
  s_branch T_CK2
T_RT3:
  buffer_load_dwordx4 v[44:47], v116, s[48:51], s13 offen offset:2048 sc1
  buffer_load_dwordx4 v[48:51], v116, s[48:51], s12 offen offset:1024 sc1
  buffer_load_dwordx4 v[52:55], v116, s[48:51], s12 offen offset:3072 sc1
  buffer_load_dwordx4 v[56:59], v116, s[48:51], s13 offen offset:1024 sc1
  buffer_load_dwordx4 v[60:63], v116, s[48:51], s13 offen offset:3072 sc1
  s_branch T_CK3
T_RT4:
  buffer_load_dwordx4 v[48:51], v116, s[48:51], s12 offen offset:1024 sc1
  buffer_load_dwordx4 v[52:55], v116, s[48:51], s12 offen offset:3072 sc1
  buffer_load_dwordx4 v[56:59], v116, s[48:51], s13 offen offset:1024 sc1
  buffer_load_dwordx4 v[60:63], v116, s[48:51], s13 offen offset:3072 sc1
  s_branch T_CK4
T_RT5:
  buffer_load_dwordx4 v[52:55], v116, s[48:51], s12 offen offset:3072 sc1
  buffer_load_dwordx4 v[56:59], v116, s[48:51], s13 offen offset:1024 sc1
  buffer_load_dwordx4 v[60:63], v116, s[48:51], s13 offen offset:3072 sc1
  s_branch T_CK5
T_RT6:
  buffer_load_dwordx4 v[56:59], v116, s[48:51], s13 offen offset:1024 sc1
  buffer_load_dwordx4 v[60:63], v116, s[48:51], s13 offen offset:3072 sc1
  s_branch T_CK6
T_RT7:
  buffer_load_dwordx4 v[60:63], v116, s[48:51], s13 offen offset:3072 sc1
  s_branch T_CK7
T_ART:
  buffer_load_dwordx2 v[12:13], v118, s[48:51], s14 offen sc1
  buffer_load_dwordx2 v[14:15], v118, s[48:51], s20 offen sc1
  s_waitcnt vmcnt(0)
  v_max_u32 v16, v12, v14
  v_cmp_eq_u32 vcc, -1, v16
  s_cbranch_vccnz T_ART
  v_lshlrev_b32 v80, 16, v12
  v_and_b32 v81, 0xffff0000, v12
  v_lshlrev_b32 v82, 16, v13
  v_and_b32 v83, 0xffff0000, v13
  v_lshlrev_b32 v84, 16, v14
  v_and_b32 v85, 0xffff0000, v14
  v_lshlrev_b32 v86, 16, v15
  v_and_b32 v87, 0xffff0000, v15
  v_mul_f32 v80, v80, v18
  v_mul_f32 v81, v81, v18
  v_mul_f32 v82, v82, v18
  v_mul_f32 v83, v83, v18
  v_mul_f32 v84, v84, v18
  v_mul_f32 v85, v85, v18
  v_mul_f32 v86, v86, v18
  v_mul_f32 v87, v87, v18
  s_branch T_AOK
F_END:
  s_endpgm
.section .rodata,"a"
.p2align 6
.amdhsa_kernel mix_f_kernel
  .amdhsa_next_free_vgpr 256
  .amdhsa_next_free_sgpr 102
  .amdhsa_accum_offset 128
  .amdhsa_group_segment_fixed_size 0
  .amdhsa_kernarg_size 120
  .amdhsa_user_sgpr_count 2
  .amdhsa_user_sgpr_kernarg_segment_ptr 1
  .amdhsa_system_sgpr_workgroup_id_x 1
.end_amdhsa_kernel
.text
```
